```python
import torch

def _softmax(x, axis=-1):
    return torch.softmax(x, dim=axis)
def _gelu(x):
    return torch.nn.functional.gelu(x, approximate="tanh")
def _silu(x):
    return torch.nn.functional.silu(x)
def _sigmoid(x):
    return torch.sigmoid(x)
def _layernorm(x, axis=-1, eps=1e-5):
    m = x.mean(dim=axis, keepdim=True)
    v = x.var(dim=axis, keepdim=True, unbiased=False)
    return (x - m) / torch.sqrt(v + eps)
def _scatter_add(tgt, idx, src, axis=0):
    return tgt.clone().index_add_(axis, idx, src)
def _segment_sum(src, seg, n):
    out = torch.zeros((n,) + src.shape[1:], dtype=src.dtype)
    return out.index_add_(0, seg, src)
def _pad(x, pw):
    flat = tuple(v for pair in reversed(pw) for v in pair)
    return torch.nn.functional.pad(x, flat)

kernel_name = 'standalone__edge_featured_mpnn_mpnn__graph'

def setup_inputs():

    _w = (lambda a: (lambda t: t.to(torch.bfloat16) if t.is_floating_point() else t)(torch.as_tensor(a)))
    N, deg, D, De = 10000, 16, 128, max(0, 1)
    E = N * deg
    H = 2 * D
    return {
        "x": _w((lambda *s: torch.randn(*s, dtype=torch.bfloat16) * 0.05)(N, D)),
        "e_attr": _w((lambda *s: torch.randn(*s, dtype=torch.bfloat16) * 1.6)(E, De)),
        "src": _w((lambda lo, hi, *s: torch.randint(lo, hi, s))(0, N, E).to(torch.int64)),
        "dst": _w((lambda lo, hi, *s: torch.randint(lo, hi, s))(0, N, E).to(torch.int64)),
        "w1": _w((lambda *s: torch.randn(*s, dtype=torch.bfloat16) * 1.6)(2 * D + De, H) * (1.0 / (2 * D + De) ** 0.5)),
        "b1": _w((lambda *s: torch.randn(*s, dtype=torch.bfloat16) * 1.6)(H) * 0.01),
        "w2": _w((lambda *s: torch.randn(*s, dtype=torch.bfloat16) * 0.05)(H, D) * (1.0 / H ** 0.5)),
        "b2": _w((lambda *s: torch.randn(*s, dtype=torch.bfloat16) * 0.05)(D) * 0.01),
    }

def reference(x, e_attr, src, dst, w1, b1, w2, b2):
    N, D = x.shape
    h_src = x[src]
    h_dst = x[dst]
    m_in = torch.concatenate([h_src, h_dst, e_attr], axis=-1)
    h = _silu(m_in @ w1 + b1)
    msg = h @ w2 + b2
    return _segment_sum(msg, dst, N)
```

```asm
; @launch kernel=k1_kernel grid=(232,1,1) block=(512,1,1) lds=65536
; @launch kernel=k2_kernel grid=(256,1,1) block=(1024,1,1) lds=159328
.amdgcn_target "amdgcn-amd-amdhsa--gfx950"
.text
.globl k1_kernel
.p2align 8
.type k1_kernel,@function
k1_kernel:
    s_cmp_ge_u32 s2, 232
    s_cbranch_scc1 K1_EXIT
    s_load_dwordx16 s[16:31], s[0:1], 0
    s_load_dwordx2 s[32:33], s[0:1], 80
    s_getpc_b64 s[64:65]
K1_PC:
    v_cmp_le_u32 vcc, 496, v0
    s_and_saveexec_b64 s[66:67], vcc
    s_cbranch_execz K1_NOVPF
    s_lshr_b32 s68, s2, 3
    s_and_b32 s68, s68, 7
    s_lshl_b32 s68, s68, 11
    v_and_b32 v141, 15, v0
    v_lshlrev_b32 v141, 7, v141
    v_add_u32 v141, s68, v141
    v_min_u32 v141, TEXT_END-K1_PC-4, v141
    global_load_dword v143, v141, s[64:65]
K1_NOVPF:
    s_mov_b64 exec, s[66:67]
K1_BODY:
    s_cmp_lt_u32 s2, 64
    s_cbranch_scc1 K1_SORT
    s_cmp_lt_u32 s2, 72
    s_cbranch_scc1 K1_TRANS
    v_lshrrev_b32 v1, 6, v0
    v_bfe_u32 v3, v0, 4, 2
    v_readfirstlane_b32 s3, v1
    v_and_b32 v6, 15, v0
    v_lshlrev_b32 v4, 2, v3
    v_xor_b32 v4, v6, v4
    v_lshlrev_b32 v4, 4, v4
    v_lshl_add_u32 v4, v3, 9, v4
    v_xor_b32 v7, v6, v3
    v_lshlrev_b32 v7, 4, v7
    v_lshl_add_u32 v7, v3, 8, v7
    s_sub_u32 s4, s2, 72
    s_bfe_u32 s11, s4, 0x10003
    s_lshr_b32 s5, s4, 4
    s_lshl_b32 s5, s5, 3
    s_and_b32 s4, s4, 7
    s_or_b32 s4, s4, s5
    s_lshl_b32 s5, s4, 15
    s_lshl_b32 s6, s3, 12
    s_add_u32 s5, s5, s6
    s_lshr_b32 s7, s2, 4
    s_add_u32 s7, s7, s3
    s_and_b32 s7, s7, 7
    s_lshl_b32 s8, s7, 12
    s_lshl_b32 s7, s7, 13
    s_lshl_b32 s9, s11, 8
    s_add_u32 s7, s7, s9
    s_add_u32 s6, s6, 32768
    s_waitcnt lgkmcnt(0)
    s_mov_b32 s40, s24
    s_mov_b32 s41, s25
    s_mov_b32 s42, 0x20200
    s_mov_b32 s43, 0x20000
    s_mov_b32 s36, s16
    s_mov_b32 s37, s17
    s_mov_b32 s38, 0x271000
    s_mov_b32 s39, 0x20000
    s_mov_b32 m0, s8
    s_add_u32 s8, s8, 1024
    buffer_load_dwordx4 v4, s[40:43], s7 offen lds
    s_add_u32 s7, s7, 2048
    s_mov_b32 m0, s6
    v_xor_b32 v8, 0, v7
    buffer_load_dwordx4 v8, s[36:39], s5 offen lds
    s_add_u32 s6, s6, 1024
    s_add_u32 s5, s5, 1024
    s_mov_b32 m0, s8
    s_add_u32 s8, s8, 1024
    buffer_load_dwordx4 v4, s[40:43], s7 offen lds
    s_add_u32 s7, s7, 2048
    s_mov_b32 m0, s6
    v_xor_b32 v8, 64, v7
    buffer_load_dwordx4 v8, s[36:39], s5 offen lds
    s_add_u32 s6, s6, 1024
    s_add_u32 s5, s5, 1024
    s_mov_b32 m0, s8
    s_add_u32 s8, s8, 1024
    buffer_load_dwordx4 v4, s[40:43], s7 offen lds
    s_add_u32 s7, s7, 2048
    s_mov_b32 m0, s6
    v_xor_b32 v8, 128, v7
    buffer_load_dwordx4 v8, s[36:39], s5 offen lds
    s_add_u32 s6, s6, 1024
    s_add_u32 s5, s5, 1024
    s_mov_b32 m0, s8
    s_add_u32 s8, s8, 1024
    buffer_load_dwordx4 v4, s[40:43], s7 offen lds
    s_add_u32 s7, s7, 2048
    s_mov_b32 m0, s6
    v_xor_b32 v8, 192, v7
    buffer_load_dwordx4 v8, s[36:39], s5 offen lds
    s_mov_b32 s44, s32
    s_mov_b32 s45, s33
    s_mov_b32 s46, 0x4e2000
    s_mov_b32 s47, 0x20000
    v_lshrrev_b32 v9, 2, v6
    v_and_b32 v10, 3, v6
    v_and_b32 v2, 3, v1
    v_xor_b32 v11, v2, v9
    v_lshl_or_b32 v10, v11, 2, v10
    v_lshlrev_b32 v10, 4, v10
    v_lshl_add_u32 v9, v3, 3, v9
    v_lshl_add_u32 v9, v9, 8, v10
    v_xor_b32 v10, v3, v6
    v_lshlrev_b32 v10, 4, v10
    v_lshl_add_u32 v10, v6, 8, v10
    s_lshr_b32 s8, s3, 2
    s_lshl_b32 s9, s8, 14
    s_add_u32 s9, s9, 32768
    v_add_u32 v10, s9, v10
    v_xor_b32 v11, 64, v10
    v_xor_b32 v12, 128, v10
    v_xor_b32 v13, 192, v10
    v_lshlrev_b32 v14, 9, v6
    v_lshl_add_u32 v14, v2, 6, v14
    v_lshl_add_u32 v14, v3, 4, v14
    s_lshl_b32 s5, s4, 16
    s_lshl_b32 s8, s8, 15
    s_add_u32 s5, s5, s8
    s_lshl_b32 s9, s11, 8
    s_add_u32 s5, s5, s9
    v_mov_b32 v15, 0xbfb8aa3b
    s_waitcnt vmcnt(0)
    s_barrier
    ds_read_b64_tr_b16 v[16:17], v9 offset:0
    ds_read_b64_tr_b16 v[18:19], v9 offset:1024
    ds_read_b64_tr_b16 v[32:33], v9 offset:8
    ds_read_b64_tr_b16 v[34:35], v9 offset:1032
    ds_read_b128 v[48:51], v10
    ds_read_b64_tr_b16 v[20:21], v9 offset:8192
    ds_read_b64_tr_b16 v[22:23], v9 offset:9216
    ds_read_b64_tr_b16 v[36:37], v9 offset:8200
    ds_read_b64_tr_b16 v[38:39], v9 offset:9224
    ds_read_b128 v[52:55], v11
    ds_read_b64_tr_b16 v[24:25], v9 offset:16384
    ds_read_b64_tr_b16 v[26:27], v9 offset:17408
    ds_read_b64_tr_b16 v[40:41], v9 offset:16392
    ds_read_b64_tr_b16 v[42:43], v9 offset:17416
    ds_read_b128 v[56:59], v12
    ds_read_b64_tr_b16 v[28:29], v9 offset:24576
    ds_read_b64_tr_b16 v[30:31], v9 offset:25600
    ds_read_b64_tr_b16 v[44:45], v9 offset:24584
    ds_read_b64_tr_b16 v[46:47], v9 offset:25608
    ds_read_b128 v[60:63], v13
    s_waitcnt lgkmcnt(15)
    v_mfma_f32_16x16x32_bf16 v[112:115], v[16:19], v[48:51], 0
    v_mfma_f32_16x16x32_bf16 v[116:119], v[32:35], v[48:51], 0
    s_waitcnt lgkmcnt(10)
    v_mfma_f32_16x16x32_bf16 v[112:115], v[20:23], v[52:55], v[112:115]
    v_mfma_f32_16x16x32_bf16 v[116:119], v[36:39], v[52:55], v[116:119]
    s_waitcnt lgkmcnt(5)
    v_mfma_f32_16x16x32_bf16 v[112:115], v[24:27], v[56:59], v[112:115]
    v_mfma_f32_16x16x32_bf16 v[116:119], v[40:43], v[56:59], v[116:119]
    s_waitcnt lgkmcnt(0)
    v_mfma_f32_16x16x32_bf16 v[112:115], v[28:31], v[60:63], v[112:115]
    v_mfma_f32_16x16x32_bf16 v[116:119], v[44:47], v[60:63], v[116:119]
    ds_read_b128 v[64:67], v10 offset:4096
    ds_read_b128 v[68:71], v11 offset:4096
    ds_read_b128 v[72:75], v12 offset:4096
    ds_read_b128 v[76:79], v13 offset:4096
    ds_read_b128 v[80:83], v10 offset:8192
    ds_read_b128 v[84:87], v11 offset:8192
    ds_read_b128 v[88:91], v12 offset:8192
    ds_read_b128 v[92:95], v13 offset:8192
    ds_read_b128 v[96:99], v10 offset:12288
    ds_read_b128 v[100:103], v11 offset:12288
    ds_read_b128 v[104:107], v12 offset:12288
    ds_read_b128 v[108:111], v13 offset:12288
    s_waitcnt lgkmcnt(8)
    v_mfma_f32_16x16x32_bf16 v[120:123], v[16:19], v[64:67], 0
    v_mfma_f32_16x16x32_bf16 v[124:127], v[32:35], v[64:67], 0
    v_mfma_f32_16x16x32_bf16 v[120:123], v[20:23], v[68:71], v[120:123]
    v_mfma_f32_16x16x32_bf16 v[124:127], v[36:39], v[68:71], v[124:127]
    v_mul_f32 v112, v15, v112
    v_mul_f32 v113, v15, v113
    v_mul_f32 v114, v15, v114
    v_mul_f32 v115, v15, v115
    v_mul_f32 v116, v15, v116
    v_mfma_f32_16x16x32_bf16 v[120:123], v[24:27], v[72:75], v[120:123]
    v_mfma_f32_16x16x32_bf16 v[124:127], v[40:43], v[72:75], v[124:127]
    v_mul_f32 v117, v15, v117
    v_mul_f32 v118, v15, v118
    v_mul_f32 v119, v15, v119
    v_cvt_pk_bf16_f32 v112, v112, v113
    v_cvt_pk_bf16_f32 v113, v114, v115
    v_mfma_f32_16x16x32_bf16 v[120:123], v[28:31], v[76:79], v[120:123]
    v_mfma_f32_16x16x32_bf16 v[124:127], v[44:47], v[76:79], v[124:127]
    v_cvt_pk_bf16_f32 v114, v116, v117
    v_cvt_pk_bf16_f32 v115, v118, v119
    s_add_u32 s6, s5, 0
    buffer_store_dwordx4 v[112:115], v14, s[44:47], s6 offen nt
    s_waitcnt lgkmcnt(4)
    v_mfma_f32_16x16x32_bf16 v[128:131], v[16:19], v[80:83], 0
    v_mfma_f32_16x16x32_bf16 v[132:135], v[32:35], v[80:83], 0
    v_mfma_f32_16x16x32_bf16 v[128:131], v[20:23], v[84:87], v[128:131]
    v_mfma_f32_16x16x32_bf16 v[132:135], v[36:39], v[84:87], v[132:135]
    v_mul_f32 v120, v15, v120
    v_mul_f32 v121, v15, v121
    v_mul_f32 v122, v15, v122
    v_mul_f32 v123, v15, v123
    v_mul_f32 v124, v15, v124
    v_mfma_f32_16x16x32_bf16 v[128:131], v[24:27], v[88:91], v[128:131]
    v_mfma_f32_16x16x32_bf16 v[132:135], v[40:43], v[88:91], v[132:135]
    v_mul_f32 v125, v15, v125
    v_mul_f32 v126, v15, v126
    v_mul_f32 v127, v15, v127
    v_cvt_pk_bf16_f32 v120, v120, v121
    v_cvt_pk_bf16_f32 v121, v122, v123
    v_mfma_f32_16x16x32_bf16 v[128:131], v[28:31], v[92:95], v[128:131]
    v_mfma_f32_16x16x32_bf16 v[132:135], v[44:47], v[92:95], v[132:135]
    v_cvt_pk_bf16_f32 v122, v124, v125
    v_cvt_pk_bf16_f32 v123, v126, v127
    s_add_u32 s6, s5, 8192
    buffer_store_dwordx4 v[120:123], v14, s[44:47], s6 offen nt
    s_waitcnt lgkmcnt(0)
    v_mfma_f32_16x16x32_bf16 v[136:139], v[16:19], v[96:99], 0
    v_mfma_f32_16x16x32_bf16 v[140:143], v[32:35], v[96:99], 0
    v_mfma_f32_16x16x32_bf16 v[136:139], v[20:23], v[100:103], v[136:139]
    v_mfma_f32_16x16x32_bf16 v[140:143], v[36:39], v[100:103], v[140:143]
    v_mul_f32 v128, v15, v128
    v_mul_f32 v129, v15, v129
    v_mul_f32 v130, v15, v130
    v_mul_f32 v131, v15, v131
    v_mul_f32 v132, v15, v132
    v_mfma_f32_16x16x32_bf16 v[136:139], v[24:27], v[104:107], v[136:139]
    v_mfma_f32_16x16x32_bf16 v[140:143], v[40:43], v[104:107], v[140:143]
    v_mul_f32 v133, v15, v133
    v_mul_f32 v134, v15, v134
    v_mul_f32 v135, v15, v135
    v_cvt_pk_bf16_f32 v128, v128, v129
    v_cvt_pk_bf16_f32 v129, v130, v131
    v_mfma_f32_16x16x32_bf16 v[136:139], v[28:31], v[108:111], v[136:139]
    v_mfma_f32_16x16x32_bf16 v[140:143], v[44:47], v[108:111], v[140:143]
    v_cvt_pk_bf16_f32 v130, v132, v133
    v_cvt_pk_bf16_f32 v131, v134, v135
    s_add_u32 s6, s5, 16384
    buffer_store_dwordx4 v[128:131], v14, s[44:47], s6 offen nt
    s_nop 7
    v_mul_f32 v136, v15, v136
    v_mul_f32 v137, v15, v137
    v_mul_f32 v138, v15, v138
    v_mul_f32 v139, v15, v139
    v_mul_f32 v140, v15, v140
    v_mul_f32 v141, v15, v141
    v_mul_f32 v142, v15, v142
    v_mul_f32 v143, v15, v143
    v_cvt_pk_bf16_f32 v136, v136, v137
    v_cvt_pk_bf16_f32 v137, v138, v139
    v_cvt_pk_bf16_f32 v138, v140, v141
    v_cvt_pk_bf16_f32 v139, v142, v143
    s_add_u32 s6, s5, 24576
    buffer_store_dwordx4 v[136:139], v14, s[44:47], s6 offen nt
    s_endpgm
K1_TRANS:
    s_sub_u32 s3, s2, 64
    v_lshrrev_b32 v1, 6, v0
    s_and_b32 s4, s3, 3
    v_readfirstlane_b32 s11, v1
    s_lshl_b32 s4, s4, 7
    v_add_u32 v1, s4, v0
    s_mov_b32 s9, 0x05040100
    s_mov_b32 s10, 0x07060302
    s_waitcnt lgkmcnt(0)
    s_cmp_ge_u32 s11, 2
    s_cbranch_scc1 K1_TR_SMALL
    s_cmp_ge_u32 s3, 4
    s_cbranch_scc1 K1_TR_W2
    v_and_b32 v2, 31, v1
    v_lshrrev_b32 v3, 5, v1
    v_lshlrev_b32 v4, 4, v2
    v_lshl_add_u32 v4, v3, 12, v4
    v_add_u32 v4, 0x10000, v4
    v_lshrrev_b32 v5, 1, v2
    v_lshlrev_b32 v5, 12, v5
    v_lshl_add_u32 v5, v3, 8, v5
    v_and_b32 v6, 1, v2
    v_lshl_add_u32 v5, v6, 7, v5
    s_mov_b32 s36, s24
    s_mov_b32 s37, s25
    s_mov_b32 s38, 0x20200
    s_mov_b32 s39, 0x20000
    s_add_u32 s40, s32, 0x900000
    s_addc_u32 s41, s33, 0
    s_mov_b32 s42, 0x10000
    s_mov_b32 s43, 0x20000
    s_mov_b32 s5, 512
    s_branch K1_TR_GO
K1_TR_W2:
    v_and_b32 v2, 15, v1
    v_bfe_u32 v3, v1, 4, 3
    v_lshrrev_b32 v7, 7, v1
    v_lshlrev_b32 v4, 4, v2
    v_lshl_add_u32 v4, v3, 13, v4
    v_lshl_add_u32 v4, v7, 11, v4
    v_lshrrev_b32 v5, 1, v2
    v_lshlrev_b32 v5, 13, v5
    v_lshl_add_u32 v5, v3, 10, v5
    v_lshl_add_u32 v5, v7, 8, v5
    v_and_b32 v6, 1, v2
    v_lshl_add_u32 v5, v6, 7, v5
    s_mov_b32 s36, s28
    s_mov_b32 s37, s29
    s_mov_b32 s38, 0x10000
    s_mov_b32 s39, 0x20000
    s_add_u32 s40, s32, 0x910000
    s_addc_u32 s41, s33, 0
    s_mov_b32 s42, 0x10000
    s_mov_b32 s43, 0x20000
    s_mov_b32 s5, 256
K1_TR_GO:
    s_mov_b32 s6, 0
    buffer_load_dwordx4 v[16:19], v4, s[36:39], s6 offen
    s_add_u32 s6, s6, s5
    buffer_load_dwordx4 v[20:23], v4, s[36:39], s6 offen
    s_add_u32 s6, s6, s5
    buffer_load_dwordx4 v[24:27], v4, s[36:39], s6 offen
    s_add_u32 s6, s6, s5
    buffer_load_dwordx4 v[28:31], v4, s[36:39], s6 offen
    s_add_u32 s6, s6, s5
    buffer_load_dwordx4 v[32:35], v4, s[36:39], s6 offen
    s_add_u32 s6, s6, s5
    buffer_load_dwordx4 v[36:39], v4, s[36:39], s6 offen
    s_add_u32 s6, s6, s5
    buffer_load_dwordx4 v[40:43], v4, s[36:39], s6 offen
    s_add_u32 s6, s6, s5
    buffer_load_dwordx4 v[44:47], v4, s[36:39], s6 offen
    s_waitcnt vmcnt(0)
    v_perm_b32 v48, v20, v16, s9
    v_perm_b32 v49, v28, v24, s9
    v_perm_b32 v50, v36, v32, s9
    v_perm_b32 v51, v44, v40, s9
    buffer_store_dwordx4 v[48:51], v5, s[40:43], 0 offen offset:0
    v_perm_b32 v52, v20, v16, s10
    v_perm_b32 v53, v28, v24, s10
    v_perm_b32 v54, v36, v32, s10
    v_perm_b32 v55, v44, v40, s10
    buffer_store_dwordx4 v[52:55], v5, s[40:43], 0 offen offset:16
    v_perm_b32 v56, v21, v17, s9
    v_perm_b32 v57, v29, v25, s9
    v_perm_b32 v58, v37, v33, s9
    v_perm_b32 v59, v45, v41, s9
    buffer_store_dwordx4 v[56:59], v5, s[40:43], 0 offen offset:32
    v_perm_b32 v60, v21, v17, s10
    v_perm_b32 v61, v29, v25, s10
    v_perm_b32 v62, v37, v33, s10
    v_perm_b32 v63, v45, v41, s10
    buffer_store_dwordx4 v[60:63], v5, s[40:43], 0 offen offset:48
    v_perm_b32 v64, v22, v18, s9
    v_perm_b32 v65, v30, v26, s9
    v_perm_b32 v66, v38, v34, s9
    v_perm_b32 v67, v46, v42, s9
    buffer_store_dwordx4 v[64:67], v5, s[40:43], 0 offen offset:64
    v_perm_b32 v68, v22, v18, s10
    v_perm_b32 v69, v30, v26, s10
    v_perm_b32 v70, v38, v34, s10
    v_perm_b32 v71, v46, v42, s10
    buffer_store_dwordx4 v[68:71], v5, s[40:43], 0 offen offset:80
    v_perm_b32 v72, v23, v19, s9
    v_perm_b32 v73, v31, v27, s9
    v_perm_b32 v74, v39, v35, s9
    v_perm_b32 v75, v47, v43, s9
    buffer_store_dwordx4 v[72:75], v5, s[40:43], 0 offen offset:96
    v_perm_b32 v76, v23, v19, s10
    v_perm_b32 v77, v31, v27, s10
    v_perm_b32 v78, v39, v35, s10
    v_perm_b32 v79, v47, v43, s10
    buffer_store_dwordx4 v[76:79], v5, s[40:43], 0 offen offset:112
    s_endpgm
K1_TR_SMALL:
    s_cmp_lg_u32 s3, 0
    s_cbranch_scc1 K1_EXIT
    s_cmp_lt_u32 s11, 4
    s_cbranch_scc1 K1_EXIT
    v_and_b32 v1, 255, v0
    v_lshlrev_b32 v2, 1, v1
    s_add_u32 s6, s24, 0x20000
    s_addc_u32 s7, s25, 0
    global_load_ushort v8, v2, s[6:7]
    global_load_ushort v9, v2, s[26:27]
    s_add_u32 s6, s32, 0x920000
    s_addc_u32 s7, s33, 0
    v_mov_b32 v10, 0xbfb8aa3b
    v_lshlrev_b32 v3, 2, v1
    s_waitcnt vmcnt(0)
    v_lshlrev_b32 v8, 16, v8
    v_lshlrev_b32 v9, 16, v9
    v_mul_f32 v8, v10, v8
    v_mul_f32 v9, v10, v9
    v_cvt_pk_bf16_f32 v8, v8, v8
    global_store_short v2, v8, s[6:7]
    global_store_dword v3, v9, s[6:7] offset:1024
    s_endpgm
K1_SORT:
    v_lshlrev_b32 v1, 2, v0
    v_mov_b32 v2, 0
    ds_write_b32 v1, v2 offset:32768
    v_lshlrev_b32 v3, 4, v0
    v_lshlrev_b32 v4, 3, v0
    v_mov_b32 v5, 1
    s_mul_i32 s3, s2, 10000
    s_mul_i32 s4, s2, 5000
    s_lshl_b32 s5, s2, 8
    s_add_u32 s6, s3, 8192
    s_add_u32 s7, s4, 4096
    s_mov_b32 s8, 0x05040100
    s_mov_b32 s9, 0x05040302
    s_waitcnt lgkmcnt(0)
    s_mov_b32 s36, s22
    s_mov_b32 s37, s23
    s_mov_b32 s38, 0x9c400
    s_mov_b32 s39, 0x20000
    s_mov_b32 s40, s20
    s_mov_b32 s41, s21
    s_mov_b32 s42, 0x9c400
    s_mov_b32 s43, 0x20000
    s_mov_b32 s44, s18
    s_mov_b32 s45, s19
    s_mov_b32 s46, 0x4e200
    s_mov_b32 s47, 0x20000
    s_add_u32 s48, s32, 0x500000
    s_addc_u32 s49, s33, 0
    s_mov_b32 s50, 0x400000
    s_mov_b32 s51, 0x20000
    v_lshlrev_b32 v6, 1, v0
    buffer_load_dwordx4 v[16:19], v3, s[36:39], s3 offen
    buffer_load_dword v20, v1, s[36:39], s6 offen
    buffer_load_dwordx4 v[24:27], v3, s[40:43], s3 offen
    buffer_load_dwordx2 v[32:33], v4, s[44:47], s4 offen
    buffer_load_dword v28, v1, s[40:43], s6 offen
    buffer_load_ushort v34, v6, s[44:47], s7 offen
    v_cmp_gt_u32 vcc, 452, v0
    v_mov_b32 v40, 0
    v_mov_b32 v48, 0
    v_mov_b32 v7, 24
    s_mov_b64 s[10:11], vcc
    s_barrier
    s_waitcnt vmcnt(5)
    v_and_b32 v44, 0xff, v16
    v_lshlrev_b32 v8, 2, v44
    ds_add_rtn_u32 v36, v8, v5 offset:32768
    v_and_b32 v45, 0xff, v17
    v_lshlrev_b32 v8, 2, v45
    ds_add_rtn_u32 v37, v8, v5 offset:32768
    v_and_b32 v46, 0xff, v18
    v_lshlrev_b32 v8, 2, v46
    ds_add_rtn_u32 v38, v8, v5 offset:32768
    v_and_b32 v47, 0xff, v19
    v_lshlrev_b32 v8, 2, v47
    ds_add_rtn_u32 v39, v8, v5 offset:32768
    s_waitcnt vmcnt(4)
    s_mov_b64 exec, s[10:11]
    v_and_b32 v48, 0xff, v20
    v_lshlrev_b32 v8, 2, v48
    ds_add_rtn_u32 v40, v8, v5 offset:32768
    s_mov_b64 exec, -1
    v_lshrrev_b32 v16, 6, v16
    v_and_b32 v16, 0xfc, v16
    v_lshlrev_b32 v44, 7, v44
    v_lshrrev_b32 v17, 6, v17
    v_and_b32 v17, 0xfc, v17
    v_lshlrev_b32 v45, 7, v45
    v_lshrrev_b32 v18, 6, v18
    v_and_b32 v18, 0xfc, v18
    v_lshlrev_b32 v46, 7, v46
    v_lshrrev_b32 v19, 6, v19
    v_and_b32 v19, 0xfc, v19
    v_lshlrev_b32 v47, 7, v47
    v_lshrrev_b32 v20, 6, v20
    v_and_b32 v20, 0xfc, v20
    v_lshlrev_b32 v48, 7, v48
    s_waitcnt vmcnt(0)
    v_perm_b32 v52, v24, v32, s8
    v_perm_b32 v53, v25, v32, s9
    v_perm_b32 v54, v26, v33, s8
    v_perm_b32 v55, v27, v33, s9
    v_perm_b32 v56, v28, v34, s8
    s_waitcnt lgkmcnt(0)
    v_and_b32 v8, 7, v36
    v_lshl_add_u32 v8, v8, 4, v44
    v_lshrrev_b32 v9, 3, v36
    v_lshl_add_u32 v60, v9, 2, v8
    v_add_u32 v68, v9, v8
    v_cmpx_gt_u32 vcc, v7, v36
    ds_write_b32 v60, v52
    ds_write_b8 v68, v16 offset:12
    s_mov_b64 exec, -1
    v_and_b32 v8, 7, v37
    v_lshl_add_u32 v8, v8, 4, v45
    v_lshrrev_b32 v9, 3, v37
    v_lshl_add_u32 v61, v9, 2, v8
    v_add_u32 v69, v9, v8
    v_cmpx_gt_u32 vcc, v7, v37
    ds_write_b32 v61, v53
    ds_write_b8 v69, v17 offset:12
    s_mov_b64 exec, -1
    v_and_b32 v8, 7, v38
    v_lshl_add_u32 v8, v8, 4, v46
    v_lshrrev_b32 v9, 3, v38
    v_lshl_add_u32 v62, v9, 2, v8
    v_add_u32 v70, v9, v8
    v_cmpx_gt_u32 vcc, v7, v38
    ds_write_b32 v62, v54
    ds_write_b8 v70, v18 offset:12
    s_mov_b64 exec, -1
    v_and_b32 v8, 7, v39
    v_lshl_add_u32 v8, v8, 4, v47
    v_lshrrev_b32 v9, 3, v39
    v_lshl_add_u32 v63, v9, 2, v8
    v_add_u32 v71, v9, v8
    v_cmpx_gt_u32 vcc, v7, v39
    ds_write_b32 v63, v55
    ds_write_b8 v71, v19 offset:12
    s_mov_b64 exec, -1
    v_and_b32 v8, 7, v40
    v_lshl_add_u32 v8, v8, 4, v48
    v_lshrrev_b32 v9, 3, v40
    v_lshl_add_u32 v64, v9, 2, v8
    v_add_u32 v72, v9, v8
    s_mov_b64 exec, s[10:11]
    v_cmpx_gt_u32 vcc, v7, v40
    ds_write_b32 v64, v56
    ds_write_b8 v72, v20 offset:12
    s_mov_b64 exec, -1
    v_max3_u32 v8, v36, v37, v38
    v_max3_u32 v8, v8, v39, v40
    v_cmp_le_u32 vcc, v7, v8
    s_cbranch_vccz K1_NOOV
    v_lshlrev_b32 v12, 7, v44
    v_sub_u32 v12, v12, v44
    v_sub_u32 v13, 47, v36
    v_subrev_u32 v14, 24, v36
    v_or_b32 v13, v13, v14
    v_and_b32 v13, 0x80000000, v13
    v_or_b32 v12, v12, v13
    v_add_u32 v10, v60, v12
    v_add_u32 v11, v68, v12
    buffer_store_dword v52, v10, s[48:51], s5 offen offset:116
    buffer_store_byte v16, v11, s[48:51], s5 offen offset:137
    v_lshlrev_b32 v12, 7, v45
    v_sub_u32 v12, v12, v45
    v_sub_u32 v13, 47, v37
    v_subrev_u32 v14, 24, v37
    v_or_b32 v13, v13, v14
    v_and_b32 v13, 0x80000000, v13
    v_or_b32 v12, v12, v13
    v_add_u32 v10, v61, v12
    v_add_u32 v11, v69, v12
    buffer_store_dword v53, v10, s[48:51], s5 offen offset:116
    buffer_store_byte v17, v11, s[48:51], s5 offen offset:137
    v_lshlrev_b32 v12, 7, v46
    v_sub_u32 v12, v12, v46
    v_sub_u32 v13, 47, v38
    v_subrev_u32 v14, 24, v38
    v_or_b32 v13, v13, v14
    v_and_b32 v13, 0x80000000, v13
    v_or_b32 v12, v12, v13
    v_add_u32 v10, v62, v12
    v_add_u32 v11, v70, v12
    buffer_store_dword v54, v10, s[48:51], s5 offen offset:116
    buffer_store_byte v18, v11, s[48:51], s5 offen offset:137
    v_lshlrev_b32 v12, 7, v47
    v_sub_u32 v12, v12, v47
    v_sub_u32 v13, 47, v39
    v_subrev_u32 v14, 24, v39
    v_or_b32 v13, v13, v14
    v_and_b32 v13, 0x80000000, v13
    v_or_b32 v12, v12, v13
    v_add_u32 v10, v63, v12
    v_add_u32 v11, v71, v12
    buffer_store_dword v55, v10, s[48:51], s5 offen offset:116
    buffer_store_byte v19, v11, s[48:51], s5 offen offset:137
    v_lshlrev_b32 v12, 7, v48
    v_sub_u32 v12, v12, v48
    v_sub_u32 v13, 47, v40
    v_subrev_u32 v14, 24, v40
    v_or_b32 v13, v13, v14
    v_and_b32 v13, 0x80000000, v13
    v_or_b32 v12, v12, v13
    v_add_u32 v10, v64, v12
    v_add_u32 v11, v72, v12
    buffer_store_dword v56, v10, s[48:51], s5 offen offset:116
    buffer_store_byte v20, v11, s[48:51], s5 offen offset:137
K1_NOOV:
    v_lshrrev_b32 v6, 3, v0
    v_lshlrev_b32 v7, 2, v6
    v_and_b32 v8, 0x70, v3
    v_lshl_add_u32 v8, v6, 14, v8
    v_mov_b32 v9, 0xffffff
    s_waitcnt vmcnt(0) lgkmcnt(0)
    s_barrier
    ds_read_b128 v[16:19], v3 offset:0
    ds_read_b32 v32, v7 offset:32768
    ds_read_b128 v[20:23], v3 offset:8192
    ds_read_b32 v33, v7 offset:33024
    ds_read_b128 v[24:27], v3 offset:16384
    ds_read_b32 v34, v7 offset:33280
    ds_read_b128 v[28:31], v3 offset:24576
    ds_read_b32 v35, v7 offset:33536
    s_waitcnt lgkmcnt(6)
    v_min_u32 v32, 0xff, v32
    v_lshlrev_b32 v32, 24, v32
    v_and_or_b32 v19, v19, v9, v32
    buffer_store_dwordx4 v[16:19], v8, s[48:51], s5 offen
    s_add_u32 s5, s5, 1048576
    s_waitcnt lgkmcnt(4)
    v_min_u32 v33, 0xff, v33
    v_lshlrev_b32 v33, 24, v33
    v_and_or_b32 v23, v23, v9, v33
    buffer_store_dwordx4 v[20:23], v8, s[48:51], s5 offen
    s_add_u32 s5, s5, 1048576
    s_waitcnt lgkmcnt(2)
    v_min_u32 v34, 0xff, v34
    v_lshlrev_b32 v34, 24, v34
    v_and_or_b32 v27, v27, v9, v34
    buffer_store_dwordx4 v[24:27], v8, s[48:51], s5 offen
    s_add_u32 s5, s5, 1048576
    s_waitcnt lgkmcnt(0)
    v_min_u32 v35, 0xff, v35
    v_lshlrev_b32 v35, 24, v35
    v_and_or_b32 v31, v31, v9, v35
    buffer_store_dwordx4 v[28:31], v8, s[48:51], s5 offen
    s_endpgm
K1_EXIT:
    s_endpgm
.globl k2_kernel
.p2align 8
.type k2_kernel,@function
k2_kernel:
    s_cmp_ge_u32 s2, 256
    s_cbranch_scc1 K2_EXIT
    s_load_dwordx16 s[16:31], s[0:1], 0
    s_load_dwordx2 s[32:33], s[0:1], 64
    s_load_dwordx2 s[34:35], s[0:1], 80
    s_getpc_b64 s[6:7]
K2_PC:
    v_cmp_le_u32 vcc, 960, v0
    s_and_saveexec_b64 s[8:9], vcc
    s_cbranch_execz K2_NOVPF
    s_lshr_b32 s10, s2, 3
    s_and_b32 s10, s10, 1
    s_mul_i32 s10, s10, 8192
    v_and_b32 v1, 63, v0
    v_lshlrev_b32 v1, 7, v1
    v_add_u32 v1, s10, v1
    v_min_u32 v1, TEXT_END-K2_PC-4, v1
    global_load_dword v100, v1, s[6:7]
K2_NOVPF:
    s_mov_b64 exec, s[8:9]
    v_lshlrev_b32 v4, 4, v0
    v_mov_b32 v102, 0
    v_mov_b32 v103, 0
    v_mov_b32 v104, 0
    v_mov_b32 v105, 0
    v_lshrrev_b32 v1, 6, v0
    v_and_b32 v5, 0x3f0, v4
    v_mov_b32 v126, v5
    ds_write_b128 v5, v[102:105] offset:20704
    v_readfirstlane_b32 s3, v1
    v_and_b32 v57, 0x1f0, v4
    v_lshlrev_b32 v2, 5, v0
    v_and_b32 v3, 0xffffff00, v2
    s_lshl_b32 s4, s2, 14
    s_add_u32 s4, s4, 0x500000
    s_lshl_b32 s5, s2, 8
    v_and_b32 v2, 0x70, v4
    v_add_u32 v3, v3, v2
    s_waitcnt lgkmcnt(0)
    s_mov_b32 s40, s34
    s_mov_b32 s41, s35
    s_mov_b32 s42, 0x921000
    s_mov_b32 s43, 0x20000
    s_add_u32 s6, s34, 0x920000
    s_addc_u32 s7, s35, 0
    s_cmp_ge_u32 s3, 8
    s_cbranch_scc1 K2_GEMMER
    buffer_load_dwordx4 v[8:11], v3, s[40:43], s4 offen
    global_load_dwordx4 v[48:51], v57, s[6:7]
    s_barrier
    ds_write_b128 v4, v[102:105]
    ds_write_b128 v4, v[102:105] offset:8192
    ds_write_b128 v4, v[102:105] offset:12608
K2_C1:
    s_mov_b32 s44, s34
    s_mov_b32 s45, s35
    s_or_b32 s45, s45, 0x2000000
    s_mov_b32 s46, 0x2710
    s_mov_b32 s47, 0x20000
    s_mov_b32 s48, s32
    s_mov_b32 s49, s33
    s_mov_b32 s50, 0x271000
    s_mov_b32 s51, 0x20000
    s_mov_b32 s62, 0
    s_mov_b32 s93, s3
    s_mov_b32 s63, 0
    s_mov_b64 s[100:101], 0
    v_mov_b32 v59, v57
    v_mov_b32 v56, 0
    v_mov_b32 v58, 0
    v_lshlrev_b32 v122, 1, v57
    v_add_u32 v122, 63328, v122
    s_mov_b32 s10, 0x00f0000f
    s_mov_b32 s11, 0xf0000f00
    s_mov_b32 s12, 0x00300003
    s_mov_b32 s13, 0x30000300
    s_mov_b32 s14, 0x00c0000c
    s_mov_b32 s15, 0xc0000c00
    v_and_b32 v6, 16, v4
    v_mov_b32 v54, 0x3f80
    v_lshlrev_b32 v54, v6, v54
    v_cndmask_b32 v60, 0, v54, s[12:13]
    v_cndmask_b32 v61, 0, v54, s[14:15]
    v_cndmask_b32 v64, 0, v54, s[12:13]
    v_cndmask_b32 v65, 0, v54, s[14:15]
    v_cndmask_b32 v68, 0, v54, s[12:13]
    v_cndmask_b32 v69, 0, v54, s[14:15]
    v_lshrrev_b32 v6, 1, v6
    v_mov_b32 v124, 21184
    v_or_b32 v54, 4, v6
    v_cndmask_b32 v124, v124, v54, s[12:13]
    v_cndmask_b32 v124, v124, v6, s[14:15]
    v_cndmask_b32 v120, 0, 4, s[10:11]
    v_bfe_u32 v125, v0, 5, 1
    v_mov_b32 v7, 4
    v_lshrrev_b32 v5, 2, v5
    s_cmp_ge_u32 s3, 8
    s_cbranch_scc1 K2_G2
    v_and_b32 v2, 7, v0
    s_waitcnt vmcnt(1)
    v_lshrrev_b32 v16, 24, v11
    v_sub_u32 v2, v16, v2
    v_cmp_lt_u32 vcc, 48, v16
    v_cmp_lt_i32 s[52:53], 0, v2
    v_cmp_lt_i32 s[54:55], 8, v2
    v_cmp_lt_i32 s[10:11], 16, v2
    v_cmp_lt_i32 s[12:13], 24, v2
    s_cmp_lg_u64 s[12:13], 0
    s_cbranch_scc1 K2_L1
K2_NOL1:
K2_RANK:
    v_bfe_u32 v23, v11, 0, 8
    s_mov_b64 exec, s[52:53]
    ds_add_rtn_u32 v17, v23, v7 offset:20800
    s_mov_b64 exec, -1
    v_bfe_u32 v24, v11, 8, 8
    s_mov_b64 exec, s[54:55]
    ds_add_rtn_u32 v18, v24, v7 offset:20800
    s_mov_b64 exec, -1
    s_cmp_eq_u64 s[10:11], 0
    s_cbranch_scc1 K2_SK1
    v_bfe_u32 v25, v11, 16, 8
    s_mov_b64 exec, s[10:11]
    ds_add_rtn_u32 v19, v25, v7 offset:20800
    s_mov_b64 exec, -1
    s_cmp_lg_u64 s[12:13], 0
    s_cbranch_scc1 K2_OL2
K2_SK1:
    s_cmp_lg_u32 s62, 0
    s_cbranch_scc1 K2_SLOW_B0
    s_waitcnt lgkmcnt(0)
    s_mov_b64 exec, 1
    ds_add_u32 v7, v7 offset:21696
    s_mov_b64 exec, -1
    s_waitcnt vmcnt(0)
    v_pk_mov_b32 v[70:71], v[48:49], v[48:49] op_sel:[0,1]
    v_pk_mov_b32 v[76:77], v[50:51], v[50:51] op_sel:[0,1]
    v_pk_mov_b32 v[78:79], v[48:49], v[48:49] op_sel:[0,1]
    v_pk_mov_b32 v[84:85], v[50:51], v[50:51] op_sel:[0,1]
    v_pk_mov_b32 v[86:87], v[48:49], v[48:49] op_sel:[0,1]
    v_pk_mov_b32 v[92:93], v[50:51], v[50:51] op_sel:[0,1]
    v_pk_mov_b32 v[94:95], v[48:49], v[48:49] op_sel:[0,1]
    v_pk_mov_b32 v[100:101], v[50:51], v[50:51] op_sel:[0,1]
K2_C2:
    s_mov_b32 s8, 0x100000
K2_SP3:
    ds_read_b32 v6, v7 offset:21696
    s_sub_u32 s8, s8, 1
    s_cbranch_scc1 K2_SP3X
    s_waitcnt lgkmcnt(0)
    v_readfirstlane_b32 s9, v6
    s_nop 0
    s_cmp_lt_u32 s9, 32
    s_cbranch_scc1 K2_SP3
K2_SP3X:
K2_SCAN:
    ds_read_b32 v53, v5 offset:20800
    ds_read_b32 v3, v7 offset:21692
    s_waitcnt lgkmcnt(0)
    v_mov_b32 v121, v53
    v_readfirstlane_b32 s8, v3
    v_cmp_ne_u32 s[56:57], 0, v53
    v_add_u32_dpp v121, v121, v121 row_shr:1 row_mask:0xf bank_mask:0xf bound_ctrl:0
    s_nop 1
    v_add_u32_dpp v121, v121, v121 row_shr:2 row_mask:0xf bank_mask:0xf bound_ctrl:0
    s_nop 1
    v_add_u32_dpp v121, v121, v121 row_shr:4 row_mask:0xf bank_mask:0xf bound_ctrl:0
    s_nop 1
    v_add_u32_dpp v121, v121, v121 row_shr:8 row_mask:0xf bank_mask:0xf bound_ctrl:0
    s_nop 1
    v_add_u32_dpp v121, v121, v121 row_bcast:15 row_mask:0xa bank_mask:0xf
    s_nop 1
    v_add_u32_dpp v121, v121, v121 row_bcast:31 row_mask:0xc bank_mask:0xf
    v_sub_u32 v123, v121, v53
    v_readlane_b32 s58, v121, 63
    s_nop 0
    s_cmp_gt_u32 s58, 4096
    s_cselect_b32 s8, 1, s8
    s_andn2_b32 s8, s8, s100
    s_cbranch_scc1 K2_SLOW_S
    s_cmp_ge_u32 s93, 8
    s_cbranch_scc1 K2_C3
    ds_bpermute_b32 v29, v23, v123
    ds_bpermute_b32 v30, v24, v123
    s_cmp_eq_u64 s[10:11], 0
    s_cbranch_scc1 K2_SK4
    ds_bpermute_b32 v31, v25, v123
    s_cmp_lg_u64 s[12:13], 0
    s_cbranch_scc1 K2_OL5
K2_SK4:
    s_waitcnt lgkmcnt(0)
    v_add_u32 v29, v29, v17
    v_lshlrev_b32 v17, 2, v29
    s_mov_b64 exec, s[52:53]
    ds_write_b16_d16_hi v29, v8 offset:16640
    ds_write_b16 v17, v8 offset:4
    ds_write_b16 v17, v8 offset:14
    s_mov_b64 exec, -1
    v_add_u32 v30, v30, v18
    v_lshlrev_b32 v18, 2, v30
    s_mov_b64 exec, s[54:55]
    ds_write_b16_d16_hi v30, v9 offset:16640
    ds_write_b16 v18, v9 offset:4
    ds_write_b16 v18, v9 offset:14
    s_mov_b64 exec, -1
    s_cmp_eq_u64 s[10:11], 0
    s_cbranch_scc1 K2_SK6
    v_add_u32 v31, v31, v19
    v_lshlrev_b32 v19, 2, v31
    s_mov_b64 exec, s[10:11]
    ds_write_b16_d16_hi v31, v10 offset:16640
    ds_write_b16 v19, v10 offset:4
    ds_write_b16 v19, v10 offset:14
    s_mov_b64 exec, -1
    s_cmp_lg_u64 s[12:13], 0
    s_cbranch_scc1 K2_OL7
K2_SK6:
    s_cmp_lg_u32 s3, 0
    s_cbranch_scc1 K2_NODEG
    ds_add_u32 v5, v53 offset:21440
K2_NODEG:
    s_cmp_lg_u32 s62, 0
    s_cbranch_scc1 K2_SLOW_B1
    s_waitcnt lgkmcnt(0)
    s_mov_b64 exec, 1
    ds_add_u32 v7, v7 offset:21700
    s_mov_b64 exec, -1
K2_C3:
    s_lshr_b32 s58, s58, 2
    s_add_u32 s67, s58, 1
    s_lshr_b32 s67, s67, 1
    s_mul_i32 s74, s67, s3
    s_add_u32 s77, s74, s67
    s_lshr_b32 s74, s74, 4
    s_lshr_b32 s77, s77, 4
    s_add_u32 s75, s74, s77
    s_min_u32 s75, s75, s58
    s_lshl_b32 s75, s75, 2
    s_lshl_b32 s77, s77, 1
    s_min_u32 s77, s77, s58
    s_lshl_b32 s77, s77, 2
    s_lshl_b32 s74, s74, 3
    s_mov_b32 s76, s75
    s_sub_u32 s59, s75, s74
    v_mul_u32_u24 v119, s59, v125
    v_add_u32 v119, s74, v119
    v_mad_u32_u24 v118, v119, v120, v124
    v_add_u32 v119, 16640, v119
    s_mov_b32 s8, 0x100000
K2_SP8:
    ds_read_b32 v6, v7 offset:21700
    s_sub_u32 s8, s8, 1
    s_cbranch_scc1 K2_SP8X
    s_waitcnt lgkmcnt(0)
    v_readfirstlane_b32 s9, v6
    s_nop 0
    s_cmp_lt_u32 s9, 32
    s_cbranch_scc1 K2_SP8
K2_SP8X:
    ds_read2_b32 v[40:41], v119 offset0:0 offset1:1
    ds_read2_b32 v[42:43], v119 offset0:2 offset1:3
    ds_read2_b32 v[62:63], v118 offset0:0 offset1:1
    ds_read2_b32 v[66:67], v118 offset0:4 offset1:5
    s_waitcnt lgkmcnt(2)
    v_mov_b32 v56, v40
    buffer_load_dwordx4 v[72:75], v[56:57], s[44:47], 0 idxen offen
    v_mov_b32 v58, v41
    buffer_load_dwordx4 v[80:83], v[58:59], s[44:47], 0 idxen offen
    v_mov_b32 v56, v42
    buffer_load_dwordx4 v[88:91], v[56:57], s[44:47], 0 idxen offen
    v_mov_b32 v58, v43
    buffer_load_dwordx4 v[96:99], v[58:59], s[44:47], 0 idxen offen
    ds_read_b32 v56, v119 offset:16
    ds_read_b32 v58, v119 offset:20
    v_cmp_lt_u32 s[70:71], s74, v121
    v_cmp_lt_u32 s[72:73], s75, v121
    s_and_b64 s[70:71], s[70:71], s[56:57]
    s_mov_b32 s78, 0
    s_mov_b32 s80, 0
    s_lshl2_add_u32 s59, s78, s74
    s_mov_b32 s4, -1
    s_cmp_ge_u32 s59, s76
    s_cselect_b32 s78, 0x7fffffff, s78
    s_cbranch_scc1 K2_INI10
    s_ff1_i32_b64 s59, s[70:71]
    s_and_b32 s59, s59, 63
    s_bitset0_b64 s[70:71], s59
    v_readlane_b32 s58, v121, s59
    s_mul_i32 s4, s59, 1040
    s_add_u32 s78, s78, 1
    s_min_u32 s58, s58, s76
    s_sub_u32 s58, s58, s74
    s_ashr_i32 s58, s58, 2
    s_max_i32 s78, s78, s58
K2_INI10:
    s_max_i32 s82, s4, 0
    s_sub_u32 s82, s82, 41600
    s_cmp_lt_i32 s4, 0
    s_cbranch_scc1 K2_INJ9
    v_readlane_b32 s58, v123, s59
    s_add_u32 s59, s59, 1
    v_mov_b32 v4, s59
    s_lshl_b32 s59, s3, 1
    s_add_u32 s59, s59, 0
    s_cmp_ge_u32 s58, s74
    s_cbranch_scc1 K2_INJ9
    s_mov_b32 s80, 1
    s_mul_i32 s82, s59, 1040
    s_add_u32 s82, s82, 41600
    s_lshl_b32 s59, s59, 2
    v_mov_b32 v6, s59
    ds_write_b32 v6, v4 offset:21056
K2_INJ9:
    s_max_i32 s4, s4, 0
    s_and_b64 s[72:73], s[72:73], s[56:57]
    s_mov_b32 s79, 0
    s_mov_b32 s81, 0
    s_lshl2_add_u32 s59, s79, s75
    s_mov_b32 s5, -1
    s_cmp_ge_u32 s59, s77
    s_cselect_b32 s79, 0x7fffffff, s79
    s_cbranch_scc1 K2_INI12
    s_ff1_i32_b64 s59, s[72:73]
    s_and_b32 s59, s59, 63
    s_bitset0_b64 s[72:73], s59
    v_readlane_b32 s58, v121, s59
    s_mul_i32 s5, s59, 1040
    s_add_u32 s79, s79, 1
    s_min_u32 s58, s58, s77
    s_sub_u32 s58, s58, s75
    s_ashr_i32 s58, s58, 2
    s_max_i32 s79, s79, s58
K2_INI12:
    s_max_i32 s83, s5, 0
    s_sub_u32 s83, s83, 41600
    s_cmp_lt_i32 s5, 0
    s_cbranch_scc1 K2_INJ11
    v_readlane_b32 s58, v123, s59
    s_add_u32 s59, s59, 1
    v_mov_b32 v4, s59
    s_lshl_b32 s59, s3, 1
    s_add_u32 s59, s59, 1
    s_cmp_ge_u32 s58, s75
    s_cbranch_scc1 K2_INJ11
    s_mov_b32 s81, 1
    s_mul_i32 s83, s59, 1040
    s_add_u32 s83, s83, 41600
    s_lshl_b32 s59, s59, 2
    v_mov_b32 v6, s59
    ds_write_b32 v6, v4 offset:21056
K2_INJ11:
    s_max_i32 s5, s5, 0
    v_add_u32 v1, s4, v122
    v_add_u32 v2, s82, v122
    s_mov_b32 exec_lo, 0
    s_mov_b32 exec_hi, -1
    v_add_u32 v1, s5, v122
    v_add_u32 v2, s83, v122
    s_mov_b64 exec, -1
    v_lshlrev_b32 v3, 4, v120
    s_min_u32 s61, s78, s79
    s_sub_u32 s60, s61, 1
    s_sub_u32 s66, s76, s74
    s_lshr_b32 s66, s66, 2
    s_sub_u32 s65, s66, 4
    s_max_i32 s65, s65, 0
    s_sub_u32 s6, s80, 1
    s_sub_u32 s7, s81, 1
    s_and_b64 s[6:7], s[6:7], s[100:101]
    v_mov_b32 v5, 21184
    v_cndmask_b32 v4, v5, v2, s[6:7]
    s_mov_b32 s8, 0x100000
K2_SP13:
    ds_read_b32 v6, v7 offset:21708
    s_sub_u32 s8, s8, 1
    s_cbranch_scc1 K2_SP13X
    s_waitcnt lgkmcnt(0)
    v_readfirstlane_b32 s9, v6
    s_nop 0
    s_cmp_lt_u32 s9, 32
    s_cbranch_scc1 K2_SP13
K2_SP13X:
K2_JOIN:
    ds_read_b128 v[32:35], v4
    ds_read_b128 v[36:39], v4 offset:16
    s_waitcnt lgkmcnt(0)
    s_setprio 2
    s_cmp_eq_u32 s61, 0x7fffffff
    s_cbranch_scc1 K2_LOOP_DONE
    ds_read_b128 v[40:43], v1
    ds_read_b128 v[44:47], v1 offset:16
    s_waitcnt vmcnt(3) lgkmcnt(0)
    v_mfma_f32_16x16x32_bf16 v[8:11], v[62:65], v[70:73], v[40:43]
    v_mfma_f32_16x16x32_bf16 v[12:15], v[60:63], v[74:77], v[44:47]
    s_sub_u32 s65, s65, 1
    s_cselect_b32 s46, 0, s46
    buffer_load_dwordx4 v[72:75], v[56:57], s[44:47], 0 idxen offen
    s_sub_u32 s60, s60, 1
    s_nop 5
    s_cbranch_scc1 K2_BND0
    s_branch K2_SUB0
.p2align 3
K2_LOOP:
    v_add_u32 v118, v3, v118
    v_add_u32 v119, 16, v119
    s_sub_u32 s66, s66, 4
    s_cmp_gt_i32 s66, 8
    s_cbranch_scc1 K2_PR1_D
    s_setprio 1
    s_cmp_gt_i32 s66, 4
    s_cbranch_scc1 K2_PR1_D
    s_setprio 0
K2_PR1_D:
K2_SUB0:
    v_exp_f32 v24, v8
    s_waitcnt vmcnt(3) lgkmcnt(0)
    v_exp_f32 v25, v9
    v_mfma_f32_16x16x32_bf16 v[16:19], v[66:69], v[78:81], v[40:43]
    v_exp_f32 v26, v10
    v_mfma_f32_16x16x32_bf16 v[20:23], v[64:67], v[82:85], v[44:47]
    v_exp_f32 v27, v11
    s_sub_u32 s65, s65, 1
    v_exp_f32 v28, v12
    s_cselect_b32 s46, 0, s46
    v_exp_f32 v29, v13
    buffer_load_dwordx4 v[80:83], v[58:59], s[44:47], 0 idxen offen
    v_exp_f32 v30, v14
    ds_read2_b32 v[62:63], v118 offset0:8 offset1:9
    v_exp_f32 v31, v15
    ds_read_b32 v56, v119 offset:24
    v_pk_add_f32 v[24:25], v[24:25], 1.0 op_sel_hi:[1,0]
    v_pk_add_f32 v[26:27], v[26:27], 1.0 op_sel_hi:[1,0]
    v_pk_add_f32 v[28:29], v[28:29], 1.0 op_sel_hi:[1,0]
    v_pk_add_f32 v[30:31], v[30:31], 1.0 op_sel_hi:[1,0]
    v_rcp_f32 v24, v24
    v_rcp_f32 v25, v25
    v_rcp_f32 v26, v26
    v_rcp_f32 v27, v27
    v_rcp_f32 v28, v28
    v_rcp_f32 v29, v29
    s_sub_u32 s60, s60, 1
    v_rcp_f32 v30, v30
    s_cbranch_scc1 K2_BNDT0
    v_rcp_f32 v31, v31
    v_pk_fma_f32 v[32:33], v[8:9], v[24:25], v[32:33]
    v_pk_fma_f32 v[34:35], v[10:11], v[26:27], v[34:35]
    v_pk_fma_f32 v[36:37], v[12:13], v[28:29], v[36:37]
    v_pk_fma_f32 v[38:39], v[14:15], v[30:31], v[38:39]
K2_SUB1:
    v_exp_f32 v24, v16
    s_waitcnt vmcnt(3) lgkmcnt(0)
    v_exp_f32 v25, v17
    v_mfma_f32_16x16x32_bf16 v[8:11], v[62:65], v[86:89], v[40:43]
    v_exp_f32 v26, v18
    v_mfma_f32_16x16x32_bf16 v[12:15], v[60:63], v[90:93], v[44:47]
    v_exp_f32 v27, v19
    s_sub_u32 s65, s65, 1
    v_exp_f32 v28, v20
    s_cselect_b32 s46, 0, s46
    v_exp_f32 v29, v21
    buffer_load_dwordx4 v[88:91], v[56:57], s[44:47], 0 idxen offen
    v_exp_f32 v30, v22
    ds_read2_b32 v[66:67], v118 offset0:12 offset1:13
    v_exp_f32 v31, v23
    ds_read_b32 v58, v119 offset:28
    v_pk_add_f32 v[24:25], v[24:25], 1.0 op_sel_hi:[1,0]
    v_pk_add_f32 v[26:27], v[26:27], 1.0 op_sel_hi:[1,0]
    v_pk_add_f32 v[28:29], v[28:29], 1.0 op_sel_hi:[1,0]
    v_pk_add_f32 v[30:31], v[30:31], 1.0 op_sel_hi:[1,0]
    v_rcp_f32 v24, v24
    v_rcp_f32 v25, v25
    v_rcp_f32 v26, v26
    v_rcp_f32 v27, v27
    v_rcp_f32 v28, v28
    v_rcp_f32 v29, v29
    s_sub_u32 s60, s60, 1
    v_rcp_f32 v30, v30
    s_cbranch_scc1 K2_BNDT1
    v_rcp_f32 v31, v31
    v_pk_fma_f32 v[32:33], v[16:17], v[24:25], v[32:33]
    v_pk_fma_f32 v[34:35], v[18:19], v[26:27], v[34:35]
    v_pk_fma_f32 v[36:37], v[20:21], v[28:29], v[36:37]
    v_pk_fma_f32 v[38:39], v[22:23], v[30:31], v[38:39]
K2_SUB2:
    v_exp_f32 v24, v8
    s_waitcnt vmcnt(3) lgkmcnt(0)
    v_exp_f32 v25, v9
    v_mfma_f32_16x16x32_bf16 v[16:19], v[66:69], v[94:97], v[40:43]
    v_exp_f32 v26, v10
    v_mfma_f32_16x16x32_bf16 v[20:23], v[64:67], v[98:101], v[44:47]
    v_exp_f32 v27, v11
    s_sub_u32 s65, s65, 1
    v_exp_f32 v28, v12
    s_cselect_b32 s46, 0, s46
    v_exp_f32 v29, v13
    buffer_load_dwordx4 v[96:99], v[58:59], s[44:47], 0 idxen offen
    v_exp_f32 v30, v14
    ds_read2_b32 v[62:63], v118 offset0:16 offset1:17
    v_exp_f32 v31, v15
    ds_read_b32 v56, v119 offset:32
    v_pk_add_f32 v[24:25], v[24:25], 1.0 op_sel_hi:[1,0]
    v_pk_add_f32 v[26:27], v[26:27], 1.0 op_sel_hi:[1,0]
    v_pk_add_f32 v[28:29], v[28:29], 1.0 op_sel_hi:[1,0]
    v_pk_add_f32 v[30:31], v[30:31], 1.0 op_sel_hi:[1,0]
    v_rcp_f32 v24, v24
    v_rcp_f32 v25, v25
    v_rcp_f32 v26, v26
    v_rcp_f32 v27, v27
    v_rcp_f32 v28, v28
    v_rcp_f32 v29, v29
    s_sub_u32 s60, s60, 1
    v_rcp_f32 v30, v30
    s_cbranch_scc1 K2_BNDT2
    v_rcp_f32 v31, v31
    v_pk_fma_f32 v[32:33], v[8:9], v[24:25], v[32:33]
    v_pk_fma_f32 v[34:35], v[10:11], v[26:27], v[34:35]
    v_pk_fma_f32 v[36:37], v[12:13], v[28:29], v[36:37]
    v_pk_fma_f32 v[38:39], v[14:15], v[30:31], v[38:39]
K2_SUB3:
    v_exp_f32 v24, v16
    s_waitcnt vmcnt(3) lgkmcnt(0)
    v_exp_f32 v25, v17
    v_mfma_f32_16x16x32_bf16 v[8:11], v[62:65], v[70:73], v[40:43]
    v_exp_f32 v26, v18
    v_mfma_f32_16x16x32_bf16 v[12:15], v[60:63], v[74:77], v[44:47]
    v_exp_f32 v27, v19
    s_sub_u32 s65, s65, 1
    v_exp_f32 v28, v20
    s_cselect_b32 s46, 0, s46
    v_exp_f32 v29, v21
    buffer_load_dwordx4 v[72:75], v[56:57], s[44:47], 0 idxen offen
    v_exp_f32 v30, v22
    ds_read2_b32 v[66:67], v118 offset0:20 offset1:21
    v_exp_f32 v31, v23
    ds_read_b32 v58, v119 offset:36
    v_pk_add_f32 v[24:25], v[24:25], 1.0 op_sel_hi:[1,0]
    v_pk_add_f32 v[26:27], v[26:27], 1.0 op_sel_hi:[1,0]
    v_pk_add_f32 v[28:29], v[28:29], 1.0 op_sel_hi:[1,0]
    v_pk_add_f32 v[30:31], v[30:31], 1.0 op_sel_hi:[1,0]
    v_rcp_f32 v24, v24
    v_rcp_f32 v25, v25
    v_rcp_f32 v26, v26
    v_rcp_f32 v27, v27
    v_rcp_f32 v28, v28
    v_rcp_f32 v29, v29
    s_sub_u32 s60, s60, 1
    v_rcp_f32 v30, v30
    s_cbranch_scc1 K2_BNDT3
    v_rcp_f32 v31, v31
    v_pk_fma_f32 v[32:33], v[16:17], v[24:25], v[32:33]
    v_pk_fma_f32 v[34:35], v[18:19], v[26:27], v[34:35]
    v_pk_fma_f32 v[36:37], v[20:21], v[28:29], v[36:37]
    v_pk_fma_f32 v[38:39], v[22:23], v[30:31], v[38:39]
    s_branch K2_LOOP
K2_GEMMER:
    s_setprio 3
    s_mov_b32 s36, s16
    s_mov_b32 s37, s17
    s_mov_b32 s38, 0x271000
    s_mov_b32 s39, 0x20000
    s_barrier
    global_load_dwordx4 v[48:51], v57, s[6:7]
    v_subrev_u32 v2, 512, v0
    v_and_b32 v3, 15, v0
    v_lshrrev_b32 v6, 4, v2
    v_lshlrev_b32 v7, 16, v6
    v_lshl_add_u32 v7, v3, 4, v7
    v_add_u32 v7, s5, v7
    buffer_load_dwordx4 v[40:43], v7, s[36:39], 0 offen
    v_add_u32 v7, 0x200000, v7
    buffer_load_dwordx4 v[44:47], v7, s[36:39], 0 offen
    s_lshr_b32 s9, s2, 3
    s_add_u32 s9, s9, s3
    s_and_b32 s9, s9, 7
    s_lshl_b32 s64, s9, 13
    s_add_u32 s64, s64, 0x900000
    s_add_u32 s65, s64, 4096
    v_and_b32 v7, 0x30, v0
    s_lshl_b32 s8, s9, 7
    v_add_u32 v54, s8, v7
    global_load_dwordx4 v[110:113], v54, s[6:7] offset:1024
    global_load_dwordx4 v[114:117], v54, s[6:7] offset:1088
    buffer_load_dwordx4 v[8:11], v126, s[40:43], s64 offen offset:0
    buffer_load_dwordx4 v[12:15], v126, s[40:43], s64 offen offset:1024
    v_mul_u32_u24 v6, 272, v6
    v_lshl_add_u32 v6, v3, 4, v6
    v_add_u32 v1, 104928, v6
    v_mul_u32_u24 v127, 1040, v3
    s_add_u32 s8, s8, 63328
    v_add3_u32 v127, v127, v7, s8
    v_mul_u32_u24 v2, 272, v3
    s_mov_b32 s8, 104928
    v_add3_u32 v2, v2, v7, s8
    buffer_load_dwordx4 v[16:19], v126, s[40:43], s64 offen offset:2048
    buffer_load_dwordx4 v[20:23], v126, s[40:43], s64 offen offset:3072
    s_branch K2_C1
K2_G2:
    buffer_load_dwordx4 v[24:27], v126, s[40:43], s65 offen offset:0
    buffer_load_dwordx4 v[28:31], v126, s[40:43], s65 offen offset:1024
    buffer_load_dwordx4 v[32:35], v126, s[40:43], s65 offen offset:2048
    buffer_load_dwordx4 v[36:39], v126, s[40:43], s65 offen offset:3072
    v_mov_b32 v126, v2
    s_waitcnt vmcnt(10)
    ds_write_b128 v1, v[40:43]
    s_cmp_ge_u32 s3, 12
    s_cbranch_scc1 K2_NOXS
    ds_write_b128 v1, v[44:47] offset:8704
K2_NOXS:
    v_pk_mov_b32 v[62:63], v[48:49], v[48:49] op_sel:[0,1]
    v_pk_mov_b32 v[66:67], v[50:51], v[50:51] op_sel:[0,1]
    s_waitcnt lgkmcnt(0)
    s_mov_b64 exec, 1
    ds_add_u32 v7, v7 offset:21704
    s_mov_b64 exec, -1
    s_mov_b32 s8, 0x100000
K2_SP14:
    ds_read_b32 v6, v7 offset:21704
    s_sub_u32 s8, s8, 1
    s_cbranch_scc1 K2_SP14X
    s_waitcnt lgkmcnt(0)
    v_readfirstlane_b32 s9, v6
    s_nop 0
    s_cmp_lt_u32 s9, 32
    s_cbranch_scc1 K2_SP14
K2_SP14X:
    ds_read_b128 v[70:73], v126 offset:0
    ds_read_b128 v[74:77], v126 offset:64
    ds_read_b128 v[78:81], v126 offset:128
    ds_read_b128 v[82:85], v126 offset:192
    ds_read_b128 v[86:89], v126 offset:4352
    ds_read_b128 v[90:93], v126 offset:4416
    ds_read_b128 v[94:97], v126 offset:4480
    ds_read_b128 v[98:101], v126 offset:4544
    ds_read_b128 v[40:43], v126 offset:8704
    ds_read_b128 v[44:47], v126 offset:8768
    ds_read_b128 v[48:51], v126 offset:8832
    ds_read_b128 v[52:55], v126 offset:8896
    v_mov_b32 v123, 0xbfb8aa3b
    s_waitcnt vmcnt(0) lgkmcnt(8)
    v_mfma_f32_16x16x32_bf16 v[102:105], v[8:11], v[70:73], 0
    v_mfma_f32_16x16x32_bf16 v[106:109], v[24:27], v[70:73], 0
    v_mfma_f32_16x16x32_bf16 v[102:105], v[12:15], v[74:77], v[102:105]
    v_mfma_f32_16x16x32_bf16 v[106:109], v[28:31], v[74:77], v[106:109]
    v_mfma_f32_16x16x32_bf16 v[102:105], v[16:19], v[78:81], v[102:105]
    v_mfma_f32_16x16x32_bf16 v[106:109], v[32:35], v[78:81], v[106:109]
    v_mfma_f32_16x16x32_bf16 v[102:105], v[20:23], v[82:85], v[102:105]
    v_mfma_f32_16x16x32_bf16 v[106:109], v[36:39], v[82:85], v[106:109]
    s_waitcnt lgkmcnt(4)
    v_mfma_f32_16x16x32_bf16 v[70:73], v[8:11], v[86:89], 0
    v_mfma_f32_16x16x32_bf16 v[74:77], v[24:27], v[86:89], 0
    v_mfma_f32_16x16x32_bf16 v[70:73], v[12:15], v[90:93], v[70:73]
    v_mfma_f32_16x16x32_bf16 v[74:77], v[28:31], v[90:93], v[74:77]
    v_mfma_f32_16x16x32_bf16 v[70:73], v[16:19], v[94:97], v[70:73]
    v_mfma_f32_16x16x32_bf16 v[74:77], v[32:35], v[94:97], v[74:77]
    v_mfma_f32_16x16x32_bf16 v[70:73], v[20:23], v[98:101], v[70:73]
    v_mfma_f32_16x16x32_bf16 v[74:77], v[36:39], v[98:101], v[74:77]
    v_fma_f32 v102, v102, v123, v110
    v_fma_f32 v103, v103, v123, v111
    v_fma_f32 v104, v104, v123, v112
    v_fma_f32 v105, v105, v123, v113
    ds_write_b128 v127, v[102:105] offset:0
    v_fma_f32 v106, v106, v123, v114
    v_fma_f32 v107, v107, v123, v115
    v_fma_f32 v108, v108, v123, v116
    v_fma_f32 v109, v109, v123, v117
    ds_write_b128 v127, v[106:109] offset:64
    s_waitcnt lgkmcnt(2)
    v_mfma_f32_16x16x32_bf16 v[102:105], v[8:11], v[40:43], 0
    v_mfma_f32_16x16x32_bf16 v[106:109], v[24:27], v[40:43], 0
    v_mfma_f32_16x16x32_bf16 v[102:105], v[12:15], v[44:47], v[102:105]
    v_mfma_f32_16x16x32_bf16 v[106:109], v[28:31], v[44:47], v[106:109]
    v_mfma_f32_16x16x32_bf16 v[102:105], v[16:19], v[48:51], v[102:105]
    v_mfma_f32_16x16x32_bf16 v[106:109], v[32:35], v[48:51], v[106:109]
    v_mfma_f32_16x16x32_bf16 v[102:105], v[20:23], v[52:55], v[102:105]
    v_mfma_f32_16x16x32_bf16 v[106:109], v[36:39], v[52:55], v[106:109]
    v_fma_f32 v70, v70, v123, v110
    v_fma_f32 v71, v71, v123, v111
    v_fma_f32 v72, v72, v123, v112
    v_fma_f32 v73, v73, v123, v113
    ds_write_b128 v127, v[70:73] offset:16640
    v_fma_f32 v74, v74, v123, v114
    v_fma_f32 v75, v75, v123, v115
    v_fma_f32 v76, v76, v123, v116
    v_fma_f32 v77, v77, v123, v117
    ds_write_b128 v127, v[74:77] offset:16704
    s_nop 0
    s_mov_b32 exec_lo, 0x00ff00ff
    s_mov_b32 exec_hi, 0x00ff00ff
    v_fma_f32 v102, v102, v123, v110
    v_fma_f32 v103, v103, v123, v111
    v_fma_f32 v104, v104, v123, v112
    v_fma_f32 v105, v105, v123, v113
    ds_write_b128 v127, v[102:105] offset:33280
    v_fma_f32 v106, v106, v123, v114
    v_fma_f32 v107, v107, v123, v115
    v_fma_f32 v108, v108, v123, v116
    v_fma_f32 v109, v109, v123, v117
    ds_write_b128 v127, v[106:109] offset:33344
    s_mov_b64 exec, -1
    s_waitcnt lgkmcnt(0)
    s_mov_b64 exec, 1
    ds_add_u32 v7, v7 offset:21708
    s_mov_b64 exec, -1
    v_pk_mov_b32 v[70:71], v[62:63], v[62:63] op_sel:[0,1]
    v_pk_mov_b32 v[76:77], v[66:67], v[66:67] op_sel:[0,1]
    v_pk_mov_b32 v[78:79], v[62:63], v[62:63] op_sel:[0,1]
    v_pk_mov_b32 v[84:85], v[66:67], v[66:67] op_sel:[0,1]
    v_pk_mov_b32 v[86:87], v[62:63], v[62:63] op_sel:[0,1]
    v_pk_mov_b32 v[92:93], v[66:67], v[66:67] op_sel:[0,1]
    v_pk_mov_b32 v[94:95], v[62:63], v[62:63] op_sel:[0,1]
    v_pk_mov_b32 v[100:101], v[66:67], v[66:67] op_sel:[0,1]
    s_branch K2_C2
K2_BNDT3:
    v_rcp_f32 v31, v31
    v_pk_fma_f32 v[32:33], v[16:17], v[24:25], v[32:33]
    v_pk_fma_f32 v[34:35], v[18:19], v[26:27], v[34:35]
    v_pk_fma_f32 v[36:37], v[20:21], v[28:29], v[36:37]
    v_pk_fma_f32 v[38:39], v[22:23], v[30:31], v[38:39]
    v_add_u32 v118, v3, v118
    v_add_u32 v119, 16, v119
    s_sub_u32 s66, s66, 4
    s_cmp_gt_i32 s66, 8
    s_cbranch_scc1 K2_PR2_D
    s_setprio 1
    s_cmp_gt_i32 s66, 4
    s_cbranch_scc1 K2_PR2_D
    s_setprio 0
K2_PR2_D:
K2_BND0:
    s_mov_b64 s[68:69], 0
    s_mov_b64 s[6:7], 0
    s_cmp_lg_u32 s78, s61
    s_cbranch_scc1 K2_B0_N0
    s_mov_b32 s68, -1
    s_lshl2_add_u32 s59, s78, s74
    s_mov_b32 s4, -1
    s_cmp_ge_u32 s59, s76
    s_cselect_b32 s78, 0x7fffffff, s78
    s_cbranch_scc1 K2_B0_S0
    s_ff1_i32_b64 s59, s[70:71]
    s_and_b32 s59, s59, 63
    s_bitset0_b64 s[70:71], s59
    v_readlane_b32 s58, v121, s59
    s_mul_i32 s4, s59, 1040
    s_add_u32 s78, s78, 1
    s_min_u32 s58, s58, s76
    s_sub_u32 s58, s58, s74
    s_ashr_i32 s58, s58, 2
    s_max_i32 s78, s78, s58
K2_B0_S0:
    s_cmp_lt_i32 s4, 0
    s_cbranch_scc1 K2_B0_N0
    s_mov_b32 s6, -1
    s_mov_b32 exec_lo, -1
    s_mov_b32 exec_hi, 0
    v_add_u32 v1, s4, v122
K2_B0_N0:
    s_cmp_lg_u32 s79, s61
    s_cbranch_scc1 K2_B0_N1
    s_mov_b32 s69, -1
    s_lshl2_add_u32 s59, s79, s75
    s_mov_b32 s5, -1
    s_cmp_ge_u32 s59, s77
    s_cselect_b32 s79, 0x7fffffff, s79
    s_cbranch_scc1 K2_B0_S1
    s_ff1_i32_b64 s59, s[72:73]
    s_and_b32 s59, s59, 63
    s_bitset0_b64 s[72:73], s59
    v_readlane_b32 s58, v121, s59
    s_mul_i32 s5, s59, 1040
    s_add_u32 s79, s79, 1
    s_min_u32 s58, s58, s77
    s_sub_u32 s58, s58, s75
    s_ashr_i32 s58, s58, 2
    s_max_i32 s79, s79, s58
K2_B0_S1:
    s_cmp_lt_i32 s5, 0
    s_cbranch_scc1 K2_B0_N1
    s_mov_b32 s7, -1
    s_mov_b32 exec_lo, 0
    s_mov_b32 exec_hi, -1
    v_add_u32 v1, s5, v122
K2_B0_N1:
    s_mov_b64 exec, s[6:7]
    s_waitcnt lgkmcnt(0)
    ds_read_b128 v[40:43], v1
    ds_read_b128 v[44:47], v1 offset:16
    s_mov_b64 exec, -1
    v_exp_f32 v24, v8
    v_exp_f32 v25, v9
    v_exp_f32 v26, v10
    v_exp_f32 v27, v11
    v_exp_f32 v28, v12
    v_exp_f32 v29, v13
    v_exp_f32 v30, v14
    v_exp_f32 v31, v15
    v_pk_add_f32 v[24:25], v[24:25], 1.0 op_sel_hi:[1,0]
    v_pk_add_f32 v[26:27], v[26:27], 1.0 op_sel_hi:[1,0]
    v_pk_add_f32 v[28:29], v[28:29], 1.0 op_sel_hi:[1,0]
    v_pk_add_f32 v[30:31], v[30:31], 1.0 op_sel_hi:[1,0]
    v_rcp_f32 v24, v24
    v_rcp_f32 v25, v25
    v_rcp_f32 v26, v26
    v_rcp_f32 v27, v27
    v_rcp_f32 v28, v28
    v_rcp_f32 v29, v29
    v_rcp_f32 v30, v30
    v_rcp_f32 v31, v31
    v_pk_fma_f32 v[32:33], v[8:9], v[24:25], v[32:33]
    v_pk_fma_f32 v[34:35], v[10:11], v[26:27], v[34:35]
    v_pk_fma_f32 v[36:37], v[12:13], v[28:29], v[36:37]
    v_pk_fma_f32 v[38:39], v[14:15], v[30:31], v[38:39]
    s_mov_b64 exec, s[68:69]
    ds_write_b128 v2, v[32:35]
    ds_write_b128 v2, v[36:39] offset:16
    s_mov_b64 exec, s[6:7]
    v_subrev_u32 v2, 41600, v1
    v_cndmask_b32 v4, v5, v2, s[100:101]
    ds_read_b128 v[32:35], v4
    ds_read_b128 v[36:39], v4 offset:16
    s_mov_b64 exec, -1
    s_sub_u32 s60, -1, s61
    s_min_u32 s61, s78, s79
    s_cmp_eq_u32 s61, 0x7fffffff
    s_cbranch_scc1 K2_LOOP_DONE
    s_add_u32 s60, s60, s61
    s_waitcnt vmcnt(3) lgkmcnt(2)
    v_mfma_f32_16x16x32_bf16 v[16:19], v[66:69], v[78:81], v[40:43]
    v_mfma_f32_16x16x32_bf16 v[20:23], v[64:67], v[82:85], v[44:47]
    s_sub_u32 s65, s65, 1
    s_cselect_b32 s46, 0, s46
    buffer_load_dwordx4 v[80:83], v[58:59], s[44:47], 0 idxen offen
    ds_read2_b32 v[62:63], v118 offset0:8 offset1:9
    ds_read_b32 v56, v119 offset:24
    s_sub_u32 s60, s60, 1
    s_nop 3
    s_cbranch_scc1 K2_BND1
    s_branch K2_SUB1
K2_BNDT0:
    v_rcp_f32 v31, v31
    v_pk_fma_f32 v[32:33], v[8:9], v[24:25], v[32:33]
    v_pk_fma_f32 v[34:35], v[10:11], v[26:27], v[34:35]
    v_pk_fma_f32 v[36:37], v[12:13], v[28:29], v[36:37]
    v_pk_fma_f32 v[38:39], v[14:15], v[30:31], v[38:39]
K2_BND1:
    s_mov_b64 s[68:69], 0
    s_mov_b64 s[6:7], 0
    s_cmp_lg_u32 s78, s61
    s_cbranch_scc1 K2_B1_N0
    s_mov_b32 s68, -1
    s_lshl2_add_u32 s59, s78, s74
    s_mov_b32 s4, -1
    s_cmp_ge_u32 s59, s76
    s_cselect_b32 s78, 0x7fffffff, s78
    s_cbranch_scc1 K2_B1_S0
    s_ff1_i32_b64 s59, s[70:71]
    s_and_b32 s59, s59, 63
    s_bitset0_b64 s[70:71], s59
    v_readlane_b32 s58, v121, s59
    s_mul_i32 s4, s59, 1040
    s_add_u32 s78, s78, 1
    s_min_u32 s58, s58, s76
    s_sub_u32 s58, s58, s74
    s_ashr_i32 s58, s58, 2
    s_max_i32 s78, s78, s58
K2_B1_S0:
    s_cmp_lt_i32 s4, 0
    s_cbranch_scc1 K2_B1_N0
    s_mov_b32 s6, -1
    s_mov_b32 exec_lo, -1
    s_mov_b32 exec_hi, 0
    v_add_u32 v1, s4, v122
K2_B1_N0:
    s_cmp_lg_u32 s79, s61
    s_cbranch_scc1 K2_B1_N1
    s_mov_b32 s69, -1
    s_lshl2_add_u32 s59, s79, s75
    s_mov_b32 s5, -1
    s_cmp_ge_u32 s59, s77
    s_cselect_b32 s79, 0x7fffffff, s79
    s_cbranch_scc1 K2_B1_S1
    s_ff1_i32_b64 s59, s[72:73]
    s_and_b32 s59, s59, 63
    s_bitset0_b64 s[72:73], s59
    v_readlane_b32 s58, v121, s59
    s_mul_i32 s5, s59, 1040
    s_add_u32 s79, s79, 1
    s_min_u32 s58, s58, s77
    s_sub_u32 s58, s58, s75
    s_ashr_i32 s58, s58, 2
    s_max_i32 s79, s79, s58
K2_B1_S1:
    s_cmp_lt_i32 s5, 0
    s_cbranch_scc1 K2_B1_N1
    s_mov_b32 s7, -1
    s_mov_b32 exec_lo, 0
    s_mov_b32 exec_hi, -1
    v_add_u32 v1, s5, v122
K2_B1_N1:
    s_mov_b64 exec, s[6:7]
    s_waitcnt lgkmcnt(0)
    ds_read_b128 v[40:43], v1
    ds_read_b128 v[44:47], v1 offset:16
    s_mov_b64 exec, -1
    v_exp_f32 v24, v16
    v_exp_f32 v25, v17
    v_exp_f32 v26, v18
    v_exp_f32 v27, v19
    v_exp_f32 v28, v20
    v_exp_f32 v29, v21
    v_exp_f32 v30, v22
    v_exp_f32 v31, v23
    v_pk_add_f32 v[24:25], v[24:25], 1.0 op_sel_hi:[1,0]
    v_pk_add_f32 v[26:27], v[26:27], 1.0 op_sel_hi:[1,0]
    v_pk_add_f32 v[28:29], v[28:29], 1.0 op_sel_hi:[1,0]
    v_pk_add_f32 v[30:31], v[30:31], 1.0 op_sel_hi:[1,0]
    v_rcp_f32 v24, v24
    v_rcp_f32 v25, v25
    v_rcp_f32 v26, v26
    v_rcp_f32 v27, v27
    v_rcp_f32 v28, v28
    v_rcp_f32 v29, v29
    v_rcp_f32 v30, v30
    v_rcp_f32 v31, v31
    v_pk_fma_f32 v[32:33], v[16:17], v[24:25], v[32:33]
    v_pk_fma_f32 v[34:35], v[18:19], v[26:27], v[34:35]
    v_pk_fma_f32 v[36:37], v[20:21], v[28:29], v[36:37]
    v_pk_fma_f32 v[38:39], v[22:23], v[30:31], v[38:39]
    s_mov_b64 exec, s[68:69]
    ds_write_b128 v2, v[32:35]
    ds_write_b128 v2, v[36:39] offset:16
    s_mov_b64 exec, s[6:7]
    v_subrev_u32 v2, 41600, v1
    v_cndmask_b32 v4, v5, v2, s[100:101]
    ds_read_b128 v[32:35], v4
    ds_read_b128 v[36:39], v4 offset:16
    s_mov_b64 exec, -1
    s_sub_u32 s60, -1, s61
    s_min_u32 s61, s78, s79
    s_cmp_eq_u32 s61, 0x7fffffff
    s_cbranch_scc1 K2_LOOP_DONE
    s_add_u32 s60, s60, s61
    s_waitcnt vmcnt(3) lgkmcnt(2)
    v_mfma_f32_16x16x32_bf16 v[8:11], v[62:65], v[86:89], v[40:43]
    v_mfma_f32_16x16x32_bf16 v[12:15], v[60:63], v[90:93], v[44:47]
    s_sub_u32 s65, s65, 1
    s_cselect_b32 s46, 0, s46
    buffer_load_dwordx4 v[88:91], v[56:57], s[44:47], 0 idxen offen
    ds_read2_b32 v[66:67], v118 offset0:12 offset1:13
    ds_read_b32 v58, v119 offset:28
    s_sub_u32 s60, s60, 1
    s_nop 3
    s_cbranch_scc1 K2_BND2
    s_branch K2_SUB2
K2_BNDT1:
    v_rcp_f32 v31, v31
    v_pk_fma_f32 v[32:33], v[16:17], v[24:25], v[32:33]
    v_pk_fma_f32 v[34:35], v[18:19], v[26:27], v[34:35]
    v_pk_fma_f32 v[36:37], v[20:21], v[28:29], v[36:37]
    v_pk_fma_f32 v[38:39], v[22:23], v[30:31], v[38:39]
K2_BND2:
    s_mov_b64 s[68:69], 0
    s_mov_b64 s[6:7], 0
    s_cmp_lg_u32 s78, s61
    s_cbranch_scc1 K2_B2_N0
    s_mov_b32 s68, -1
    s_lshl2_add_u32 s59, s78, s74
    s_mov_b32 s4, -1
    s_cmp_ge_u32 s59, s76
    s_cselect_b32 s78, 0x7fffffff, s78
    s_cbranch_scc1 K2_B2_S0
    s_ff1_i32_b64 s59, s[70:71]
    s_and_b32 s59, s59, 63
    s_bitset0_b64 s[70:71], s59
    v_readlane_b32 s58, v121, s59
    s_mul_i32 s4, s59, 1040
    s_add_u32 s78, s78, 1
    s_min_u32 s58, s58, s76
    s_sub_u32 s58, s58, s74
    s_ashr_i32 s58, s58, 2
    s_max_i32 s78, s78, s58
K2_B2_S0:
    s_cmp_lt_i32 s4, 0
    s_cbranch_scc1 K2_B2_N0
    s_mov_b32 s6, -1
    s_mov_b32 exec_lo, -1
    s_mov_b32 exec_hi, 0
    v_add_u32 v1, s4, v122
K2_B2_N0:
    s_cmp_lg_u32 s79, s61
    s_cbranch_scc1 K2_B2_N1
    s_mov_b32 s69, -1
    s_lshl2_add_u32 s59, s79, s75
    s_mov_b32 s5, -1
    s_cmp_ge_u32 s59, s77
    s_cselect_b32 s79, 0x7fffffff, s79
    s_cbranch_scc1 K2_B2_S1
    s_ff1_i32_b64 s59, s[72:73]
    s_and_b32 s59, s59, 63
    s_bitset0_b64 s[72:73], s59
    v_readlane_b32 s58, v121, s59
    s_mul_i32 s5, s59, 1040
    s_add_u32 s79, s79, 1
    s_min_u32 s58, s58, s77
    s_sub_u32 s58, s58, s75
    s_ashr_i32 s58, s58, 2
    s_max_i32 s79, s79, s58
K2_B2_S1:
    s_cmp_lt_i32 s5, 0
    s_cbranch_scc1 K2_B2_N1
    s_mov_b32 s7, -1
    s_mov_b32 exec_lo, 0
    s_mov_b32 exec_hi, -1
    v_add_u32 v1, s5, v122
K2_B2_N1:
    s_mov_b64 exec, s[6:7]
    s_waitcnt lgkmcnt(0)
    ds_read_b128 v[40:43], v1
    ds_read_b128 v[44:47], v1 offset:16
    s_mov_b64 exec, -1
    v_exp_f32 v24, v8
    v_exp_f32 v25, v9
    v_exp_f32 v26, v10
    v_exp_f32 v27, v11
    v_exp_f32 v28, v12
    v_exp_f32 v29, v13
    v_exp_f32 v30, v14
    v_exp_f32 v31, v15
    v_pk_add_f32 v[24:25], v[24:25], 1.0 op_sel_hi:[1,0]
    v_pk_add_f32 v[26:27], v[26:27], 1.0 op_sel_hi:[1,0]
    v_pk_add_f32 v[28:29], v[28:29], 1.0 op_sel_hi:[1,0]
    v_pk_add_f32 v[30:31], v[30:31], 1.0 op_sel_hi:[1,0]
    v_rcp_f32 v24, v24
    v_rcp_f32 v25, v25
    v_rcp_f32 v26, v26
    v_rcp_f32 v27, v27
    v_rcp_f32 v28, v28
    v_rcp_f32 v29, v29
    v_rcp_f32 v30, v30
    v_rcp_f32 v31, v31
    v_pk_fma_f32 v[32:33], v[8:9], v[24:25], v[32:33]
    v_pk_fma_f32 v[34:35], v[10:11], v[26:27], v[34:35]
    v_pk_fma_f32 v[36:37], v[12:13], v[28:29], v[36:37]
    v_pk_fma_f32 v[38:39], v[14:15], v[30:31], v[38:39]
    s_mov_b64 exec, s[68:69]
    ds_write_b128 v2, v[32:35]
    ds_write_b128 v2, v[36:39] offset:16
    s_mov_b64 exec, s[6:7]
    v_subrev_u32 v2, 41600, v1
    v_cndmask_b32 v4, v5, v2, s[100:101]
    ds_read_b128 v[32:35], v4
    ds_read_b128 v[36:39], v4 offset:16
    s_mov_b64 exec, -1
    s_sub_u32 s60, -1, s61
    s_min_u32 s61, s78, s79
    s_cmp_eq_u32 s61, 0x7fffffff
    s_cbranch_scc1 K2_LOOP_DONE
    s_add_u32 s60, s60, s61
    s_waitcnt vmcnt(3) lgkmcnt(2)
    v_mfma_f32_16x16x32_bf16 v[16:19], v[66:69], v[94:97], v[40:43]
    v_mfma_f32_16x16x32_bf16 v[20:23], v[64:67], v[98:101], v[44:47]
    s_sub_u32 s65, s65, 1
    s_cselect_b32 s46, 0, s46
    buffer_load_dwordx4 v[96:99], v[58:59], s[44:47], 0 idxen offen
    ds_read2_b32 v[62:63], v118 offset0:16 offset1:17
    ds_read_b32 v56, v119 offset:32
    s_sub_u32 s60, s60, 1
    s_nop 3
    s_cbranch_scc1 K2_BND3
    s_branch K2_SUB3
K2_BNDT2:
    v_rcp_f32 v31, v31
    v_pk_fma_f32 v[32:33], v[8:9], v[24:25], v[32:33]
    v_pk_fma_f32 v[34:35], v[10:11], v[26:27], v[34:35]
    v_pk_fma_f32 v[36:37], v[12:13], v[28:29], v[36:37]
    v_pk_fma_f32 v[38:39], v[14:15], v[30:31], v[38:39]
K2_BND3:
    s_mov_b64 s[68:69], 0
    s_mov_b64 s[6:7], 0
    s_cmp_lg_u32 s78, s61
    s_cbranch_scc1 K2_B3_N0
    s_mov_b32 s68, -1
    s_lshl2_add_u32 s59, s78, s74
    s_mov_b32 s4, -1
    s_cmp_ge_u32 s59, s76
    s_cselect_b32 s78, 0x7fffffff, s78
    s_cbranch_scc1 K2_B3_S0
    s_ff1_i32_b64 s59, s[70:71]
    s_and_b32 s59, s59, 63
    s_bitset0_b64 s[70:71], s59
    v_readlane_b32 s58, v121, s59
    s_mul_i32 s4, s59, 1040
    s_add_u32 s78, s78, 1
    s_min_u32 s58, s58, s76
    s_sub_u32 s58, s58, s74
    s_ashr_i32 s58, s58, 2
    s_max_i32 s78, s78, s58
K2_B3_S0:
    s_cmp_lt_i32 s4, 0
    s_cbranch_scc1 K2_B3_N0
    s_mov_b32 s6, -1
    s_mov_b32 exec_lo, -1
    s_mov_b32 exec_hi, 0
    v_add_u32 v1, s4, v122
K2_B3_N0:
    s_cmp_lg_u32 s79, s61
    s_cbranch_scc1 K2_B3_N1
    s_mov_b32 s69, -1
    s_lshl2_add_u32 s59, s79, s75
    s_mov_b32 s5, -1
    s_cmp_ge_u32 s59, s77
    s_cselect_b32 s79, 0x7fffffff, s79
    s_cbranch_scc1 K2_B3_S1
    s_ff1_i32_b64 s59, s[72:73]
    s_and_b32 s59, s59, 63
    s_bitset0_b64 s[72:73], s59
    v_readlane_b32 s58, v121, s59
    s_mul_i32 s5, s59, 1040
    s_add_u32 s79, s79, 1
    s_min_u32 s58, s58, s77
    s_sub_u32 s58, s58, s75
    s_ashr_i32 s58, s58, 2
    s_max_i32 s79, s79, s58
K2_B3_S1:
    s_cmp_lt_i32 s5, 0
    s_cbranch_scc1 K2_B3_N1
    s_mov_b32 s7, -1
    s_mov_b32 exec_lo, 0
    s_mov_b32 exec_hi, -1
    v_add_u32 v1, s5, v122
K2_B3_N1:
    s_mov_b64 exec, s[6:7]
    s_waitcnt lgkmcnt(0)
    ds_read_b128 v[40:43], v1
    ds_read_b128 v[44:47], v1 offset:16
    s_mov_b64 exec, -1
    v_exp_f32 v24, v16
    v_exp_f32 v25, v17
    v_exp_f32 v26, v18
    v_exp_f32 v27, v19
    v_exp_f32 v28, v20
    v_exp_f32 v29, v21
    v_exp_f32 v30, v22
    v_exp_f32 v31, v23
    v_pk_add_f32 v[24:25], v[24:25], 1.0 op_sel_hi:[1,0]
    v_pk_add_f32 v[26:27], v[26:27], 1.0 op_sel_hi:[1,0]
    v_pk_add_f32 v[28:29], v[28:29], 1.0 op_sel_hi:[1,0]
    v_pk_add_f32 v[30:31], v[30:31], 1.0 op_sel_hi:[1,0]
    v_rcp_f32 v24, v24
    v_rcp_f32 v25, v25
    v_rcp_f32 v26, v26
    v_rcp_f32 v27, v27
    v_rcp_f32 v28, v28
    v_rcp_f32 v29, v29
    v_rcp_f32 v30, v30
    v_rcp_f32 v31, v31
    v_pk_fma_f32 v[32:33], v[16:17], v[24:25], v[32:33]
    v_pk_fma_f32 v[34:35], v[18:19], v[26:27], v[34:35]
    v_pk_fma_f32 v[36:37], v[20:21], v[28:29], v[36:37]
    v_pk_fma_f32 v[38:39], v[22:23], v[30:31], v[38:39]
    s_mov_b64 exec, s[68:69]
    ds_write_b128 v2, v[32:35]
    ds_write_b128 v2, v[36:39] offset:16
    s_mov_b64 exec, s[6:7]
    v_subrev_u32 v2, 41600, v1
    v_cndmask_b32 v4, v5, v2, s[100:101]
    ds_read_b128 v[32:35], v4
    ds_read_b128 v[36:39], v4 offset:16
    s_mov_b64 exec, -1
    s_sub_u32 s60, -1, s61
    s_min_u32 s61, s78, s79
    s_cmp_eq_u32 s61, 0x7fffffff
    s_cbranch_scc1 K2_LOOP_DONE
    s_add_u32 s60, s60, s61
    s_waitcnt vmcnt(3) lgkmcnt(2)
    v_mfma_f32_16x16x32_bf16 v[8:11], v[62:65], v[70:73], v[40:43]
    v_mfma_f32_16x16x32_bf16 v[12:15], v[60:63], v[74:77], v[44:47]
    s_sub_u32 s65, s65, 1
    s_cselect_b32 s46, 0, s46
    buffer_load_dwordx4 v[72:75], v[56:57], s[44:47], 0 idxen offen
    ds_read2_b32 v[66:67], v118 offset0:20 offset1:21
    ds_read_b32 v58, v119 offset:36
    s_sub_u32 s60, s60, 1
    s_nop 3
    s_cbranch_scc0 K2_LOOP
    v_add_u32 v118, v3, v118
    v_add_u32 v119, 16, v119
    s_sub_u32 s66, s66, 4
    s_cmp_gt_i32 s66, 8
    s_cbranch_scc1 K2_PR3_D
    s_setprio 1
    s_cmp_gt_i32 s66, 4
    s_cbranch_scc1 K2_PR3_D
    s_setprio 0
K2_PR3_D:
    s_branch K2_BND0
K2_LOOP_DONE:
    s_mov_b32 s46, 10000
    s_setprio 0
    s_cmp_lg_u32 s62, 0
    s_cbranch_scc1 K2_COMB
K2_EPI:
    s_lshl_b32 s4, 1, s3
    v_mov_b32 v6, s4
    v_mov_b32 v7, 4
    s_waitcnt lgkmcnt(0)
    s_mov_b64 exec, 1
    ds_or_b32 v7, v6 offset:21712
    s_mov_b64 exec, -1
    v_and_b32 v1, 63, v0
    s_or_b64 s[10:11], s[56:57], s[100:101]
    v_lshlrev_b32 v3, 4, v1
    s_cmp_ge_u32 s3, 4
    s_cbranch_scc1 K2_LAST
    v_readlane_b32 s58, v121, 15
    v_readlane_b32 s59, v121, 31
    v_mul_u32_u24 v6, s67, v1
    v_lshrrev_b32 v6, 4, v6
    v_lshlrev_b32 v6, 3, v6
    v_cmp_gt_u32 s[70:71], s58, v6
    v_cmp_gt_u32 s[72:73], s59, v6
    s_waitcnt vmcnt(0)
    s_lshr_b32 s4, s2, 3
    s_add_u32 s4, s4, s3
    s_and_b32 s74, s4, 3
    s_lshl_b32 s6, s74, 14
    s_add_u32 s6, s6, 0x910000
    buffer_load_dwordx4 v[56:59], v3, s[40:43], s6 offen offset:0
    buffer_load_dwordx4 v[60:63], v3, s[40:43], s6 offen offset:1024
    buffer_load_dwordx4 v[64:67], v3, s[40:43], s6 offen offset:2048
    buffer_load_dwordx4 v[68:71], v3, s[40:43], s6 offen offset:3072
    s_add_u32 s6, s6, 4096
    buffer_load_dwordx4 v[72:75], v3, s[40:43], s6 offen offset:0
    buffer_load_dwordx4 v[76:79], v3, s[40:43], s6 offen offset:1024
    buffer_load_dwordx4 v[80:83], v3, s[40:43], s6 offen offset:2048
    buffer_load_dwordx4 v[84:87], v3, s[40:43], s6 offen offset:3072
    s_add_u32 s6, s6, 4096
    buffer_load_dwordx4 v[88:91], v3, s[40:43], s6 offen offset:0
    buffer_load_dwordx4 v[92:95], v3, s[40:43], s6 offen offset:1024
    buffer_load_dwordx4 v[96:99], v3, s[40:43], s6 offen offset:2048
    buffer_load_dwordx4 v[100:103], v3, s[40:43], s6 offen offset:3072
    s_add_u32 s6, s6, 4096
    buffer_load_dwordx4 v[104:107], v3, s[40:43], s6 offen offset:0
    buffer_load_dwordx4 v[108:111], v3, s[40:43], s6 offen offset:1024
    buffer_load_dwordx4 v[112:115], v3, s[40:43], s6 offen offset:2048
    buffer_load_dwordx4 v[116:119], v3, s[40:43], s6 offen offset:3072
    v_bfe_u32 v7, v0, 4, 2
    s_lshl_b32 s7, s74, 6
    v_lshlrev_b32 v5, 3, v7
    v_add_u32 v5, s7, v5
    global_load_dwordx2 v[120:121], v5, s[30:31]
    global_load_dwordx2 v[122:123], v5, s[30:31] offset:32
    v_and_b32 v2, 15, v0
    v_mul_u32_u24 v4, 528, v2
    v_lshl_add_u32 v4, v7, 4, v4
    v_add_u32 v4, 138208, v4
    v_lshlrev_b32 v6, 2, v2
    ds_read_b32 v124, v6 offset:21440
    ds_read_b32 v125, v6 offset:21504
    ds_read_b32 v126, v6 offset:21568
    v_lshl_add_u32 v5, v2, 16, v5
    s_lshl_b32 s9, s2, 8
    v_add_u32 v5, s9, v5
    v_mov_b32 v127, 0xbf317218
    s_and_b32 s70, s70, 0xffff
    s_and_b32 s72, s72, 0xffff
    s_waitcnt lgkmcnt(0)
    v_cvt_f32_u32 v124, v124
    v_mul_f32 v124, 0.25, v124
    v_cvt_f32_u32 v125, v125
    v_mul_f32 v125, 0.25, v125
    v_cvt_f32_u32 v126, v126
    v_mul_f32 v126, 0.25, v126
    s_mov_b32 s8, 0x100000
    v_mov_b32 v7, 4
K2_DN15:
    ds_read_b32 v6, v7 offset:21712
    s_sub_u32 s8, s8, 1
    s_cbranch_scc1 K2_DN15X
    s_waitcnt lgkmcnt(0)
    v_readfirstlane_b32 s9, v6
    s_nop 0
    s_andn2_b32 s9, s70, s9
    s_cbranch_scc1 K2_DN15
K2_DN15X:
    s_add_u32 s75, s3, 0
    s_mul_i32 s4, s75, 1040
    s_add_u32 s4, s4, 21728
    v_add_u32 v6, s4, v3
    v_lshrrev_b32 v2, 2, v3
    ds_read_b32 v2, v2 offset:21056
    ds_read_b128 v[40:43], v6 offset:0
    ds_read_b128 v[44:47], v6 offset:4160
    ds_read_b128 v[48:51], v6 offset:8320
    ds_read_b128 v[52:55], v6 offset:12480
    s_add_u32 s4, s75, 1
    s_lshr_b64 s[36:37], s[10:11], s75
    s_waitcnt lgkmcnt(4)
    v_subrev_u32 v2, s4, v2
    v_cmp_eq_u32 s[6:7], 0, v2
    v_cmp_eq_u32 s[12:13], 4, v2
    v_cmp_eq_u32 s[14:15], 8, v2
    v_cmp_eq_u32 s[38:39], 12, v2
K2_CBL16:
    s_ff1_i32_b32 s8, s6
    s_bitset0_b32 s6, s8
    s_mul_i32 s9, s8, 1040
    s_add_u32 s9, s9, 104928
    s_cmp_lt_i32 s8, 0
    v_add_u32 v7, s9, v3
    s_cbranch_scc0 K2_CH17
    v_mov_b32 v7, 21184
K2_CH17:
    ds_read_b128 v[8:11], v7
    s_ff1_i32_b32 s8, s12
    s_bitset0_b32 s12, s8
    s_mul_i32 s9, s8, 1040
    s_add_u32 s9, s9, 104928
    s_cmp_lt_i32 s8, 0
    v_add_u32 v7, s9, v3
    s_cbranch_scc0 K2_CH18
    v_mov_b32 v7, 21184
K2_CH18:
    ds_read_b128 v[12:15], v7
    s_ff1_i32_b32 s8, s14
    s_bitset0_b32 s14, s8
    s_mul_i32 s9, s8, 1040
    s_add_u32 s9, s9, 104928
    s_cmp_lt_i32 s8, 0
    v_add_u32 v7, s9, v3
    s_cbranch_scc0 K2_CH19
    v_mov_b32 v7, 21184
K2_CH19:
    ds_read_b128 v[16:19], v7
    s_ff1_i32_b32 s8, s38
    s_bitset0_b32 s38, s8
    s_mul_i32 s9, s8, 1040
    s_add_u32 s9, s9, 104928
    s_cmp_lt_i32 s8, 0
    v_add_u32 v7, s9, v3
    s_cbranch_scc0 K2_CH20
    v_mov_b32 v7, 21184
K2_CH20:
    ds_read_b128 v[20:23], v7
    s_bitcmp1_b64 s[36:37], 0
    s_cbranch_scc1 K2_CZ21
    s_waitcnt lgkmcnt(4)
    v_mov_b32 v40, 0
    v_mov_b32 v41, 0
    v_mov_b32 v42, 0
    v_mov_b32 v43, 0
K2_CZ21:
    s_bitcmp1_b64 s[36:37], 4
    s_cbranch_scc1 K2_CZ22
    s_waitcnt lgkmcnt(4)
    v_mov_b32 v44, 0
    v_mov_b32 v45, 0
    v_mov_b32 v46, 0
    v_mov_b32 v47, 0
K2_CZ22:
    s_bitcmp1_b64 s[36:37], 8
    s_cbranch_scc1 K2_CZ23
    s_waitcnt lgkmcnt(4)
    v_mov_b32 v48, 0
    v_mov_b32 v49, 0
    v_mov_b32 v50, 0
    v_mov_b32 v51, 0
K2_CZ23:
    s_bitcmp1_b64 s[36:37], 12
    s_cbranch_scc1 K2_CZ24
    s_waitcnt lgkmcnt(4)
    v_mov_b32 v52, 0
    v_mov_b32 v53, 0
    v_mov_b32 v54, 0
    v_mov_b32 v55, 0
K2_CZ24:
    s_mov_b32 s8, s6
    s_or_b32 s8, s8, s12
    s_or_b32 s8, s8, s14
    s_or_b32 s8, s8, s38
    s_cmp_lg_u32 s8, 0
    s_waitcnt lgkmcnt(0)
    v_pk_add_f32 v[40:41], v[40:41], v[8:9]
    v_pk_add_f32 v[42:43], v[42:43], v[10:11]
    v_pk_add_f32 v[44:45], v[44:45], v[12:13]
    v_pk_add_f32 v[46:47], v[46:47], v[14:15]
    v_pk_add_f32 v[48:49], v[48:49], v[16:17]
    v_pk_add_f32 v[50:51], v[50:51], v[18:19]
    v_pk_add_f32 v[52:53], v[52:53], v[20:21]
    v_pk_add_f32 v[54:55], v[54:55], v[22:23]
    s_cbranch_scc1 K2_CBL16
    s_mul_i32 s4, s75, 528
    s_add_u32 s4, s4, 138208
    v_lshrrev_b32 v6, 1, v3
    v_add_u32 v6, s4, v6
    v_cvt_pk_bf16_f32 v40, v40, v41
    v_cvt_pk_bf16_f32 v41, v42, v43
    ds_write_b64 v6, v[40:41] offset:0
    v_cvt_pk_bf16_f32 v44, v44, v45
    v_cvt_pk_bf16_f32 v45, v46, v47
    ds_write_b64 v6, v[44:45] offset:2112
    v_cvt_pk_bf16_f32 v48, v48, v49
    v_cvt_pk_bf16_f32 v49, v50, v51
    ds_write_b64 v6, v[48:49] offset:4224
    v_cvt_pk_bf16_f32 v52, v52, v53
    v_cvt_pk_bf16_f32 v53, v54, v55
    ds_write_b64 v6, v[52:53] offset:6336
    v_mov_b32 v7, 4
    v_mov_b32 v6, 8
    s_waitcnt lgkmcnt(0)
    s_mov_b64 exec, 1
    ds_add_u32 v7, v6 offset:21716
    s_mov_b64 exec, -1
    s_waitcnt vmcnt(0)
    v_lshlrev_b32 v24, 16, v120
    v_and_b32 v25, 0xffff0000, v120
    v_lshlrev_b32 v26, 16, v121
    v_and_b32 v27, 0xffff0000, v121
    v_lshlrev_b32 v28, 16, v122
    v_and_b32 v29, 0xffff0000, v122
    v_lshlrev_b32 v30, 16, v123
    v_and_b32 v31, 0xffff0000, v123
    s_mov_b32 s8, 0x100000
K2_SP25:
    ds_read_b32 v6, v7 offset:21716
    s_sub_u32 s8, s8, 1
    s_cbranch_scc1 K2_SP25X
    s_waitcnt lgkmcnt(0)
    v_readfirstlane_b32 s9, v6
    s_nop 0
    s_cmp_lt_u32 s9, 32
    s_cbranch_scc1 K2_SP25
K2_SP25X:
    ds_read_b128 v[8:11], v4 offset:0
    ds_read_b128 v[12:15], v4 offset:64
    ds_read_b128 v[16:19], v4 offset:128
    ds_read_b128 v[20:23], v4 offset:192
    s_waitcnt lgkmcnt(3)
    v_mfma_f32_16x16x32_bf16 v[32:35], v[56:59], v[8:11], 0
    v_mfma_f32_16x16x32_bf16 v[36:39], v[88:91], v[8:11], 0
    ds_read_b128 v[8:11], v4 offset:256
    s_waitcnt lgkmcnt(3)
    v_mfma_f32_16x16x32_bf16 v[32:35], v[60:63], v[12:15], v[32:35]
    v_mfma_f32_16x16x32_bf16 v[36:39], v[92:95], v[12:15], v[36:39]
    ds_read_b128 v[12:15], v4 offset:320
    s_waitcnt lgkmcnt(3)
    v_mfma_f32_16x16x32_bf16 v[32:35], v[64:67], v[16:19], v[32:35]
    v_mfma_f32_16x16x32_bf16 v[36:39], v[96:99], v[16:19], v[36:39]
    ds_read_b128 v[16:19], v4 offset:384
    s_waitcnt lgkmcnt(3)
    v_mfma_f32_16x16x32_bf16 v[32:35], v[68:71], v[20:23], v[32:35]
    v_mfma_f32_16x16x32_bf16 v[36:39], v[100:103], v[20:23], v[36:39]
    ds_read_b128 v[20:23], v4 offset:448
    s_waitcnt lgkmcnt(3)
    v_mfma_f32_16x16x32_bf16 v[32:35], v[72:75], v[8:11], v[32:35]
    v_mfma_f32_16x16x32_bf16 v[36:39], v[104:107], v[8:11], v[36:39]
    v_mul_f32 v40, v124, v24
    v_mul_f32 v41, v124, v25
    s_waitcnt lgkmcnt(2)
    v_mfma_f32_16x16x32_bf16 v[32:35], v[76:79], v[12:15], v[32:35]
    v_mfma_f32_16x16x32_bf16 v[36:39], v[108:111], v[12:15], v[36:39]
    v_mul_f32 v42, v124, v26
    v_mul_f32 v43, v124, v27
    s_waitcnt lgkmcnt(1)
    v_mfma_f32_16x16x32_bf16 v[32:35], v[80:83], v[16:19], v[32:35]
    v_mfma_f32_16x16x32_bf16 v[36:39], v[112:115], v[16:19], v[36:39]
    v_mul_f32 v44, v124, v28
    v_mul_f32 v45, v124, v29
    s_waitcnt lgkmcnt(0)
    v_mfma_f32_16x16x32_bf16 v[32:35], v[84:87], v[20:23], v[32:35]
    v_mfma_f32_16x16x32_bf16 v[36:39], v[116:119], v[20:23], v[36:39]
    v_mul_f32 v46, v124, v30
    v_mul_f32 v47, v124, v31
    s_nop 5
    v_fmac_f32 v40, v127, v32
    v_fmac_f32 v41, v127, v33
    v_fmac_f32 v42, v127, v34
    v_fmac_f32 v43, v127, v35
    v_fmac_f32 v44, v127, v36
    v_fmac_f32 v45, v127, v37
    v_fmac_f32 v46, v127, v38
    v_fmac_f32 v47, v127, v39
    v_cvt_pk_bf16_f32 v40, v40, v41
    v_cvt_pk_bf16_f32 v41, v42, v43
    buffer_store_dwordx2 v[40:41], v5, s[48:51], 0 offen offset:0
    v_cvt_pk_bf16_f32 v44, v44, v45
    v_cvt_pk_bf16_f32 v45, v46, v47
    buffer_store_dwordx2 v[44:45], v5, s[48:51], 0 offen offset:32
    v_add_u32 v5, 0x100000, v5
K2_LAST:
    s_waitcnt lgkmcnt(0)
    s_barrier
    s_add_u32 s75, s3, 16
    s_cmp_lt_u32 s3, 8
    s_cbranch_scc1 K2_LAST1
    s_mul_i32 s4, s75, 1040
    s_add_u32 s4, s4, 21728
    v_add_u32 v6, s4, v3
    v_lshrrev_b32 v2, 2, v3
    ds_read_b32 v2, v2 offset:21056
    ds_read_b128 v[40:43], v6 offset:0
    ds_read_b128 v[44:47], v6 offset:8320
    s_add_u32 s4, s75, 1
    s_lshr_b64 s[36:37], s[10:11], s75
    s_waitcnt lgkmcnt(2)
    v_subrev_u32 v2, s4, v2
    v_cmp_eq_u32 s[6:7], 0, v2
    v_cmp_eq_u32 s[12:13], 8, v2
K2_CBL26:
    s_ff1_i32_b32 s8, s6
    s_bitset0_b32 s6, s8
    s_mul_i32 s9, s8, 1040
    s_add_u32 s9, s9, 104928
    s_cmp_lt_i32 s8, 0
    v_add_u32 v7, s9, v3
    s_cbranch_scc0 K2_CH27
    v_mov_b32 v7, 21184
K2_CH27:
    ds_read_b128 v[8:11], v7
    s_ff1_i32_b32 s8, s12
    s_bitset0_b32 s12, s8
    s_mul_i32 s9, s8, 1040
    s_add_u32 s9, s9, 104928
    s_cmp_lt_i32 s8, 0
    v_add_u32 v7, s9, v3
    s_cbranch_scc0 K2_CH28
    v_mov_b32 v7, 21184
K2_CH28:
    ds_read_b128 v[12:15], v7
    s_bitcmp1_b64 s[36:37], 0
    s_cbranch_scc1 K2_CZ29
    s_waitcnt lgkmcnt(2)
    v_mov_b32 v40, 0
    v_mov_b32 v41, 0
    v_mov_b32 v42, 0
    v_mov_b32 v43, 0
K2_CZ29:
    s_bitcmp1_b64 s[36:37], 8
    s_cbranch_scc1 K2_CZ30
    s_waitcnt lgkmcnt(2)
    v_mov_b32 v44, 0
    v_mov_b32 v45, 0
    v_mov_b32 v46, 0
    v_mov_b32 v47, 0
K2_CZ30:
    s_mov_b32 s8, s6
    s_or_b32 s8, s8, s12
    s_cmp_lg_u32 s8, 0
    s_waitcnt lgkmcnt(0)
    v_pk_add_f32 v[40:41], v[40:41], v[8:9]
    v_pk_add_f32 v[42:43], v[42:43], v[10:11]
    v_pk_add_f32 v[44:45], v[44:45], v[12:13]
    v_pk_add_f32 v[46:47], v[46:47], v[14:15]
    s_cbranch_scc1 K2_CBL26
    s_mul_i32 s4, s75, 528
    s_add_u32 s4, s4, 138208
    v_lshrrev_b32 v6, 1, v3
    v_add_u32 v6, s4, v6
    v_cvt_pk_bf16_f32 v40, v40, v41
    v_cvt_pk_bf16_f32 v41, v42, v43
    ds_write_b64 v6, v[40:41] offset:0
    v_cvt_pk_bf16_f32 v44, v44, v45
    v_cvt_pk_bf16_f32 v45, v46, v47
    ds_write_b64 v6, v[44:45] offset:4224
    s_branch K2_LAST2
K2_LAST1:
    s_mul_i32 s4, s75, 1040
    s_add_u32 s4, s4, 21728
    v_add_u32 v6, s4, v3
    v_lshrrev_b32 v2, 2, v3
    ds_read_b32 v2, v2 offset:21056
    ds_read_b128 v[40:43], v6 offset:0
    s_add_u32 s4, s75, 1
    s_lshr_b64 s[36:37], s[10:11], s75
    s_waitcnt lgkmcnt(1)
    v_subrev_u32 v2, s4, v2
    v_cmp_eq_u32 s[6:7], 0, v2
K2_CBL31:
    s_ff1_i32_b32 s8, s6
    s_bitset0_b32 s6, s8
    s_mul_i32 s9, s8, 1040
    s_add_u32 s9, s9, 104928
    s_cmp_lt_i32 s8, 0
    v_add_u32 v7, s9, v3
    s_cbranch_scc0 K2_CH32
    v_mov_b32 v7, 21184
K2_CH32:
    ds_read_b128 v[8:11], v7
    s_bitcmp1_b64 s[36:37], 0
    s_cbranch_scc1 K2_CZ33
    s_waitcnt lgkmcnt(1)
    v_mov_b32 v40, 0
    v_mov_b32 v41, 0
    v_mov_b32 v42, 0
    v_mov_b32 v43, 0
K2_CZ33:
    s_mov_b32 s8, s6
    s_cmp_lg_u32 s8, 0
    s_waitcnt lgkmcnt(0)
    v_pk_add_f32 v[40:41], v[40:41], v[8:9]
    v_pk_add_f32 v[42:43], v[42:43], v[10:11]
    s_cbranch_scc1 K2_CBL31
    s_mul_i32 s4, s75, 528
    s_add_u32 s4, s4, 138208
    v_lshrrev_b32 v6, 1, v3
    v_add_u32 v6, s4, v6
    v_cvt_pk_bf16_f32 v40, v40, v41
    v_cvt_pk_bf16_f32 v41, v42, v43
    ds_write_b64 v6, v[40:41] offset:0
K2_LAST2:
    s_waitcnt lgkmcnt(0)
    s_barrier
    s_cmp_ge_u32 s3, 4
    s_cbranch_scc1 K2_EXIT
    ds_read_b128 v[8:11], v4 offset:8448
    ds_read_b128 v[12:15], v4 offset:8512
    ds_read_b128 v[16:19], v4 offset:8576
    ds_read_b128 v[20:23], v4 offset:8640
    s_waitcnt lgkmcnt(3)
    v_mfma_f32_16x16x32_bf16 v[32:35], v[56:59], v[8:11], 0
    v_mfma_f32_16x16x32_bf16 v[36:39], v[88:91], v[8:11], 0
    ds_read_b128 v[8:11], v4 offset:8704
    s_waitcnt lgkmcnt(3)
    v_mfma_f32_16x16x32_bf16 v[32:35], v[60:63], v[12:15], v[32:35]
    v_mfma_f32_16x16x32_bf16 v[36:39], v[92:95], v[12:15], v[36:39]
    ds_read_b128 v[12:15], v4 offset:8768
    s_waitcnt lgkmcnt(3)
    v_mfma_f32_16x16x32_bf16 v[32:35], v[64:67], v[16:19], v[32:35]
    v_mfma_f32_16x16x32_bf16 v[36:39], v[96:99], v[16:19], v[36:39]
    ds_read_b128 v[16:19], v4 offset:8832
    s_waitcnt lgkmcnt(3)
    v_mfma_f32_16x16x32_bf16 v[32:35], v[68:71], v[20:23], v[32:35]
    v_mfma_f32_16x16x32_bf16 v[36:39], v[100:103], v[20:23], v[36:39]
    ds_read_b128 v[20:23], v4 offset:8896
    s_waitcnt lgkmcnt(3)
    v_mfma_f32_16x16x32_bf16 v[32:35], v[72:75], v[8:11], v[32:35]
    v_mfma_f32_16x16x32_bf16 v[36:39], v[104:107], v[8:11], v[36:39]
    v_mul_f32 v40, v125, v24
    v_mul_f32 v41, v125, v25
    s_waitcnt lgkmcnt(2)
    v_mfma_f32_16x16x32_bf16 v[32:35], v[76:79], v[12:15], v[32:35]
    v_mfma_f32_16x16x32_bf16 v[36:39], v[108:111], v[12:15], v[36:39]
    v_mul_f32 v42, v125, v26
    v_mul_f32 v43, v125, v27
    s_waitcnt lgkmcnt(1)
    v_mfma_f32_16x16x32_bf16 v[32:35], v[80:83], v[16:19], v[32:35]
    v_mfma_f32_16x16x32_bf16 v[36:39], v[112:115], v[16:19], v[36:39]
    v_mul_f32 v44, v125, v28
    v_mul_f32 v45, v125, v29
    s_waitcnt lgkmcnt(0)
    v_mfma_f32_16x16x32_bf16 v[32:35], v[84:87], v[20:23], v[32:35]
    v_mfma_f32_16x16x32_bf16 v[36:39], v[116:119], v[20:23], v[36:39]
    v_mul_f32 v46, v125, v30
    v_mul_f32 v47, v125, v31
    s_nop 5
    v_fmac_f32 v40, v127, v32
    v_fmac_f32 v41, v127, v33
    v_fmac_f32 v42, v127, v34
    v_fmac_f32 v43, v127, v35
    v_fmac_f32 v44, v127, v36
    v_fmac_f32 v45, v127, v37
    v_fmac_f32 v46, v127, v38
    v_fmac_f32 v47, v127, v39
    v_cvt_pk_bf16_f32 v40, v40, v41
    v_cvt_pk_bf16_f32 v41, v42, v43
    buffer_store_dwordx2 v[40:41], v5, s[48:51], 0 offen offset:0
    v_cvt_pk_bf16_f32 v44, v44, v45
    v_cvt_pk_bf16_f32 v45, v46, v47
    buffer_store_dwordx2 v[44:45], v5, s[48:51], 0 offen offset:32
    v_add_u32 v5, 0x100000, v5
    ds_read_b128 v[8:11], v4 offset:16896
    ds_read_b128 v[12:15], v4 offset:16960
    ds_read_b128 v[16:19], v4 offset:17024
    ds_read_b128 v[20:23], v4 offset:17088
    s_waitcnt lgkmcnt(3)
    v_mfma_f32_16x16x32_bf16 v[32:35], v[56:59], v[8:11], 0
    v_mfma_f32_16x16x32_bf16 v[36:39], v[88:91], v[8:11], 0
    ds_read_b128 v[8:11], v4 offset:17152
    s_waitcnt lgkmcnt(3)
    v_mfma_f32_16x16x32_bf16 v[32:35], v[60:63], v[12:15], v[32:35]
    v_mfma_f32_16x16x32_bf16 v[36:39], v[92:95], v[12:15], v[36:39]
    ds_read_b128 v[12:15], v4 offset:17216
    s_waitcnt lgkmcnt(3)
    v_mfma_f32_16x16x32_bf16 v[32:35], v[64:67], v[16:19], v[32:35]
    v_mfma_f32_16x16x32_bf16 v[36:39], v[96:99], v[16:19], v[36:39]
    ds_read_b128 v[16:19], v4 offset:17280
    s_waitcnt lgkmcnt(3)
    v_mfma_f32_16x16x32_bf16 v[32:35], v[68:71], v[20:23], v[32:35]
    v_mfma_f32_16x16x32_bf16 v[36:39], v[100:103], v[20:23], v[36:39]
    ds_read_b128 v[20:23], v4 offset:17344
    s_waitcnt lgkmcnt(3)
    v_mfma_f32_16x16x32_bf16 v[32:35], v[72:75], v[8:11], v[32:35]
    v_mfma_f32_16x16x32_bf16 v[36:39], v[104:107], v[8:11], v[36:39]
    v_mul_f32 v40, v126, v24
    v_mul_f32 v41, v126, v25
    s_waitcnt lgkmcnt(2)
    v_mfma_f32_16x16x32_bf16 v[32:35], v[76:79], v[12:15], v[32:35]
    v_mfma_f32_16x16x32_bf16 v[36:39], v[108:111], v[12:15], v[36:39]
    v_mul_f32 v42, v126, v26
    v_mul_f32 v43, v126, v27
    s_waitcnt lgkmcnt(1)
    v_mfma_f32_16x16x32_bf16 v[32:35], v[80:83], v[16:19], v[32:35]
    v_mfma_f32_16x16x32_bf16 v[36:39], v[112:115], v[16:19], v[36:39]
    v_mul_f32 v44, v126, v28
    v_mul_f32 v45, v126, v29
    s_waitcnt lgkmcnt(0)
    v_mfma_f32_16x16x32_bf16 v[32:35], v[84:87], v[20:23], v[32:35]
    v_mfma_f32_16x16x32_bf16 v[36:39], v[116:119], v[20:23], v[36:39]
    v_mul_f32 v46, v126, v30
    v_mul_f32 v47, v126, v31
    s_nop 5
    v_fmac_f32 v40, v127, v32
    v_fmac_f32 v41, v127, v33
    v_fmac_f32 v42, v127, v34
    v_fmac_f32 v43, v127, v35
    v_fmac_f32 v44, v127, v36
    v_fmac_f32 v45, v127, v37
    v_fmac_f32 v46, v127, v38
    v_fmac_f32 v47, v127, v39
    v_cvt_pk_bf16_f32 v40, v40, v41
    v_cvt_pk_bf16_f32 v41, v42, v43
    buffer_store_dwordx2 v[40:41], v5, s[48:51], 0 offen offset:0
    v_cvt_pk_bf16_f32 v44, v44, v45
    v_cvt_pk_bf16_f32 v45, v46, v47
    buffer_store_dwordx2 v[44:45], v5, s[48:51], 0 offen offset:32
K2_EXIT:
    s_endpgm
K2_COMB:
    v_and_b32 v1, 63, v0
    v_lshlrev_b32 v3, 4, v1
    s_mov_b64 s[10:11], -1
    s_waitcnt vmcnt(0) lgkmcnt(0)
    s_barrier
    s_mul_i32 s4, s3, 1040
    s_add_u32 s4, s4, 21728
    v_add_u32 v6, s4, v3
    v_lshrrev_b32 v2, 2, v3
    ds_read_b32 v2, v2 offset:21056
    ds_read_b128 v[40:43], v6 offset:0
    ds_read_b128 v[44:47], v6 offset:16640
    ds_read_b128 v[48:51], v6 offset:33280
    s_add_u32 s4, s3, 1
    s_lshr_b64 s[36:37], s[10:11], s3
    s_waitcnt lgkmcnt(3)
    v_subrev_u32 v2, s4, v2
    v_cmp_eq_u32 s[6:7], 0, v2
    v_cmp_eq_u32 s[12:13], 16, v2
    v_cmp_eq_u32 s[14:15], 32, v2
K2_CBL34:
    s_ff1_i32_b32 s8, s6
    s_bitset0_b32 s6, s8
    s_mul_i32 s9, s8, 1040
    s_add_u32 s9, s9, 104928
    s_cmp_lt_i32 s8, 0
    v_add_u32 v7, s9, v3
    s_cbranch_scc0 K2_CH35
    v_mov_b32 v7, 21184
K2_CH35:
    ds_read_b128 v[8:11], v7
    s_ff1_i32_b32 s8, s12
    s_bitset0_b32 s12, s8
    s_mul_i32 s9, s8, 1040
    s_add_u32 s9, s9, 104928
    s_cmp_lt_i32 s8, 0
    v_add_u32 v7, s9, v3
    s_cbranch_scc0 K2_CH36
    v_mov_b32 v7, 21184
K2_CH36:
    ds_read_b128 v[12:15], v7
    s_ff1_i32_b32 s8, s14
    s_bitset0_b32 s14, s8
    s_mul_i32 s9, s8, 1040
    s_add_u32 s9, s9, 104928
    s_cmp_lt_i32 s8, 0
    v_add_u32 v7, s9, v3
    s_cbranch_scc0 K2_CH37
    v_mov_b32 v7, 21184
K2_CH37:
    ds_read_b128 v[16:19], v7
    s_bitcmp1_b64 s[36:37], 0
    s_cbranch_scc1 K2_CZ38
    s_waitcnt lgkmcnt(3)
    v_mov_b32 v40, 0
    v_mov_b32 v41, 0
    v_mov_b32 v42, 0
    v_mov_b32 v43, 0
K2_CZ38:
    s_bitcmp1_b64 s[36:37], 16
    s_cbranch_scc1 K2_CZ39
    s_waitcnt lgkmcnt(3)
    v_mov_b32 v44, 0
    v_mov_b32 v45, 0
    v_mov_b32 v46, 0
    v_mov_b32 v47, 0
K2_CZ39:
    s_bitcmp1_b64 s[36:37], 32
    s_cbranch_scc1 K2_CZ40
    s_waitcnt lgkmcnt(3)
    v_mov_b32 v48, 0
    v_mov_b32 v49, 0
    v_mov_b32 v50, 0
    v_mov_b32 v51, 0
K2_CZ40:
    s_mov_b32 s8, s6
    s_or_b32 s8, s8, s12
    s_or_b32 s8, s8, s14
    s_cmp_lg_u32 s8, 0
    s_waitcnt lgkmcnt(0)
    v_pk_add_f32 v[40:41], v[40:41], v[8:9]
    v_pk_add_f32 v[42:43], v[42:43], v[10:11]
    v_pk_add_f32 v[44:45], v[44:45], v[12:13]
    v_pk_add_f32 v[46:47], v[46:47], v[14:15]
    v_pk_add_f32 v[48:49], v[48:49], v[16:17]
    v_pk_add_f32 v[50:51], v[50:51], v[18:19]
    s_cbranch_scc1 K2_CBL34
    ds_write_b128 v6, v[40:43]
    ds_write_b128 v6, v[44:47] offset:16640
    s_cmp_ge_u32 s3, 8
    s_cbranch_scc1 K2_SLOW_SYNC
    ds_write_b128 v6, v[48:51] offset:33280
    s_branch K2_SLOW_SYNC
K2_SLOW_S:
K2_SLOW_SET:
    s_mov_b32 s62, 1
K2_SLOW_SYNC:
    s_waitcnt lgkmcnt(0)
    s_barrier
K2_SLOW_NEXT:
    v_lshlrev_b32 v4, 4, v0
    v_mov_b32 v102, 0
    v_mov_b32 v103, 0
    v_mov_b32 v104, 0
    v_mov_b32 v105, 0
    ds_write_b128 v4, v[102:105] offset:5056
    ds_write_b128 v4, v[102:105]
    s_cmp_lg_u32 s63, 0
    s_cbranch_scc1 K2_SLOW_NZ
    s_mov_b64 s[100:101], -1
    ds_write_b128 v4, v[102:105] offset:21728
    ds_write_b128 v4, v[102:105] offset:38112
    ds_write_b128 v4, v[102:105] offset:46944
K2_SLOW_NZ:
    s_cmp_lt_u32 s63, 160000
    s_cbranch_scc1 K2_SLOW_GO
    s_mov_b32 s62, 0
    s_waitcnt lgkmcnt(0)
    s_barrier
    s_branch K2_EPI
K2_SLOW_GO:
    v_add_u32 v5, s63, v0
    v_mov_b32 v6, 160000
    v_cmp_lt_u32 vcc, v5, v6
    v_min_u32 v5, 159999, v5
    v_lshlrev_b32 v6, 2, v5
    v_lshlrev_b32 v7, 1, v5
    global_load_dword v40, v6, s[22:23]
    global_load_dword v42, v6, s[20:21]
    global_load_ushort v41, v7, s[18:19]
    v_and_b32 v5, 63, v0
    v_lshlrev_b32 v5, 2, v5
    s_waitcnt vmcnt(0) lgkmcnt(0)
    s_barrier
    v_and_b32 v7, 0xff, v40
    v_cmp_eq_u32 s[52:53], s2, v7
    v_lshl_or_b32 v8, v42, 16, v41
    v_lshrrev_b32 v7, 6, v40
    v_and_b32 v11, 0xfc, v7
    s_and_b64 s[52:53], s[52:53], vcc
    s_mov_b64 s[54:55], 0
    s_mov_b64 s[10:11], 0
    s_mov_b64 s[12:13], 0
    v_mov_b32 v7, 4
    s_mov_b32 s93, 0
    s_add_u32 s63, s63, 1024
    s_branch K2_RANK
K2_SLOW_B0:
    s_waitcnt lgkmcnt(0)
    s_barrier
    s_branch K2_SCAN
K2_SLOW_B1:
    v_mov_b32 v6, 32
    ds_write_b32 v7, v6 offset:21700
    s_waitcnt lgkmcnt(0)
    s_barrier
    s_branch K2_C3
K2_L1:
    v_cmp_lt_i32 s[14:15], 32, v2
    v_cmp_lt_i32 s[36:37], 40, v2
    buffer_load_dwordx4 v[12:15], v3, s[40:43], s4 offen offset:128
    s_mov_b64 exec, vcc
    ds_write_b32 v7, v7 offset:21692
    s_mov_b64 exec, -1
    s_waitcnt vmcnt(0)
    s_branch K2_NOL1
K2_OL2:
    v_bfe_u32 v26, v15, 0, 8
    s_mov_b64 exec, s[12:13]
    ds_add_rtn_u32 v20, v26, v7 offset:20800
    s_mov_b64 exec, -1
    v_bfe_u32 v27, v15, 8, 8
    s_mov_b64 exec, s[14:15]
    ds_add_rtn_u32 v21, v27, v7 offset:20800
    s_mov_b64 exec, -1
    v_bfe_u32 v28, v15, 16, 8
    s_mov_b64 exec, s[36:37]
    ds_add_rtn_u32 v22, v28, v7 offset:20800
    s_mov_b64 exec, -1
    s_branch K2_SK1
K2_OL5:
    ds_bpermute_b32 v32, v26, v123
    ds_bpermute_b32 v33, v27, v123
    ds_bpermute_b32 v34, v28, v123
    s_branch K2_SK4
K2_OL7:
    v_add_u32 v32, v32, v20
    v_lshlrev_b32 v20, 2, v32
    s_mov_b64 exec, s[12:13]
    ds_write_b16_d16_hi v32, v12 offset:16640
    ds_write_b16 v20, v12 offset:4
    ds_write_b16 v20, v12 offset:14
    s_mov_b64 exec, -1
    v_add_u32 v33, v33, v21
    v_lshlrev_b32 v21, 2, v33
    s_mov_b64 exec, s[14:15]
    ds_write_b16_d16_hi v33, v13 offset:16640
    ds_write_b16 v21, v13 offset:4
    ds_write_b16 v21, v13 offset:14
    s_mov_b64 exec, -1
    v_add_u32 v34, v34, v22
    v_lshlrev_b32 v22, 2, v34
    s_mov_b64 exec, s[36:37]
    ds_write_b16_d16_hi v34, v14 offset:16640
    ds_write_b16 v22, v14 offset:4
    ds_write_b16 v22, v14 offset:14
    s_mov_b64 exec, -1
    s_branch K2_SK6
TEXT_END:
.section .rodata,"a"
.p2align 6
.amdhsa_kernel k1_kernel
  .amdhsa_next_free_vgpr 144
  .amdhsa_next_free_sgpr 102
  .amdhsa_accum_offset 144
  .amdhsa_group_segment_fixed_size 0
  .amdhsa_kernarg_size 88
  .amdhsa_user_sgpr_count 2
  .amdhsa_user_sgpr_kernarg_segment_ptr 1
  .amdhsa_system_sgpr_workgroup_id_x 1
.end_amdhsa_kernel
.p2align 6
.amdhsa_kernel k2_kernel
  .amdhsa_next_free_vgpr 128
  .amdhsa_next_free_sgpr 102
  .amdhsa_accum_offset 128
  .amdhsa_group_segment_fixed_size 0
  .amdhsa_kernarg_size 88
  .amdhsa_user_sgpr_count 2
  .amdhsa_user_sgpr_kernarg_segment_ptr 1
  .amdhsa_system_sgpr_workgroup_id_x 1
.end_amdhsa_kernel
```
